```python
import torch

def _softmax(x, axis=-1):
    return torch.softmax(x, dim=axis)
def _gelu(x):
    return torch.nn.functional.gelu(x, approximate="tanh")
def _silu(x):
    return torch.nn.functional.silu(x)
def _sigmoid(x):
    return torch.sigmoid(x)
def _layernorm(x, axis=-1, eps=1e-5):
    m = x.mean(dim=axis, keepdim=True)
    v = x.var(dim=axis, keepdim=True, unbiased=False)
    return (x - m) / torch.sqrt(v + eps)
def _scatter_add(tgt, idx, src, axis=0):
    return tgt.clone().index_add_(axis, idx, src)
def _segment_sum(src, seg, n):
    out = torch.zeros((n,) + src.shape[1:], dtype=src.dtype)
    return out.index_add_(0, seg, src)
def _pad(x, pw):
    flat = tuple(v for pair in reversed(pw) for v in pair)
    return torch.nn.functional.pad(x, flat)

kernel_name = 'sequential_preLN__sliding_local_dilated__dense_activation_gelu__prompt'

def setup_inputs():

    _w = (lambda a: (lambda t: t.to(torch.bfloat16) if t.is_floating_point() else t)(torch.as_tensor(a)))
    def _A_setup():
        B, S, D = 1, 2048, 512
        return {
            "x": _w((lambda *s: torch.randn(*s, dtype=torch.bfloat16) * 0.05)(B, S, D)),
            "wqkv": _w((lambda *s: torch.randn(*s, dtype=torch.bfloat16) * 0.05)(D, 3 * D)),
            "wo": _w((lambda *s: torch.randn(*s, dtype=torch.bfloat16) * 0.05)(D, D)),
        }
    _A_in = _A_setup()

    def _B_setup():
        B, S, D, F = 1, 2048, 512, 1792
        return {
            "x": _w((lambda *s: torch.randn(*s, dtype=torch.bfloat16) * 0.05)(B, S, D)),
            "w1": _w((lambda *s: torch.randn(*s, dtype=torch.bfloat16) * 0.8)(D, F) * (D ** -0.5)),
            "b1": _w((lambda *s: torch.randn(*s, dtype=torch.bfloat16) * 0.8)(F) * 0.01),
            "w2": _w((lambda *s: torch.randn(*s, dtype=torch.bfloat16) * 0.8)(F, D) * (F ** -0.5)),
            "b2": _w((lambda *s: torch.randn(*s, dtype=torch.bfloat16) * 0.8)(D) * 0.01),
        }
    _B_in = _B_setup()

    return {
        "A_x": _A_in["x"],
        "A_wqkv": _A_in["wqkv"],
        "A_wo": _A_in["wo"],
        "B_x": _B_in["x"],
        "B_w1": _B_in["w1"],
        "B_b1": _B_in["b1"],
        "B_w2": _B_in["w2"],
        "B_b2": _B_in["b2"],
    }

def reference(A_x, A_wqkv, A_wo, B_x, B_w1, B_b1, B_w2, B_b2):
    def _A_ref(x, wqkv, wo):
        B, S, D = x.shape
        H = 32; Dh = D // H
        W, dil = 8, 2
        qkv = (lambda x, *d: x.permute(*d))((x @ wqkv).reshape(B, S, 3, H, Dh), 2, 0, 3, 1, 4)
        q, k, v = qkv[0], qkv[1], qkv[2]
        scale = Dh ** -0.5
        pos = torch.arange(S)
        off = torch.arange(W) * dil
        idx = pos[:, None] - off[None, :]
        mask = idx >= 0
        idx_c = torch.where(mask, idx, 0).reshape(-1)
        kg = k[:, :, idx_c, :].reshape(B, H, S, W, Dh)
        vg = v[:, :, idx_c, :].reshape(B, H, S, W, Dh)
        logits = torch.einsum("bhsd,bhswd->bhsw", q, kg) * scale
        logits = torch.where(mask[None, None, :, :], logits, -1e9)
        attn = _softmax(logits, axis=-1)
        o = torch.einsum("bhsw,bhswd->bhsd", attn, vg)
        return (lambda x, *d: x.permute(*d))(o, 0, 2, 1, 3).reshape(B, S, D) @ wo

    def _B_ref(x, w1, b1, w2, b2):
        h = torch.einsum("bsd,df->bsf", x, w1) + b1
        h = _gelu(h)
        return torch.einsum("bsf,fd->bsd", h, w2) + b2

    x = A_x
    h = x + _A_ref(_layernorm(x, axis=-1), A_wqkv, A_wo)
    h2 = h + _B_ref(_layernorm(h, axis=-1), B_w1, B_b1, B_w2, B_b2)
    return h2
```

```asm
; @launch grid=(256,1,1) block=(256,1,1) lds=163840
.amdgcn_target "amdgcn-amd-amdhsa--gfx950"
.text
.globl sequential_preLN__sliding_local_dilated__dense_activation_gelu__prompt_kernel
.p2align 8
.type sequential_preLN__sliding_local_dilated__dense_activation_gelu__prompt_kernel,@function
sequential_preLN__sliding_local_dilated__dense_activation_gelu__prompt_kernel:
    s_cmp_ge_u32 s2, 256
    s_cbranch_scc1 L_end
    s_load_dwordx16 s[4:19], s[0:1], 0
    s_load_dwordx4 s[20:23], s[0:1], 64
    s_load_dwordx2 s[24:25], s[0:1], 80
    s_getpc_b64 s[26:27]
L_pc:
    v_lshrrev_b32 v1, 6, v0
    v_and_b32 v0, 63, v0
    v_readfirstlane_b32 s56, v1
    s_lshr_b32 s62, s2, 3
    s_lshl_b32 s63, s62, 2
    s_add_u32 s63, s63, s56
    s_lshl_b32 s63, s63, 8
    v_lshlrev_b32 v1, 2, v0
    v_add_u32 v1, s63, v1
    s_mov_b32 s63, L_code_end-L_pc-4
    v_min_u32 v1, s63, v1
    global_load_dword v252, v1, s[26:27]
    s_and_b32 s57, s2, 7
    s_and_b32 s58, s62, 7
    s_and_b32 s60, s62, 15
    s_lshr_b32 s97, s62, 3
    s_lshl_b32 s59, s57, 2
    s_add_u32 s59, s59, s97
    s_lshr_b32 s61, s59, 1
    s_lshr_b32 s69, s56, 1
    s_and_b32 s70, s56, 1
    s_lshl_b32 s99, s97, 1
    s_cmp_eq_u32 s58, 3
    s_cselect_b32 s99, s99, 0
    s_add_u32 s99, s99, s57
    s_and_b32 s99, s99, 7
    s_add_u32 s62, s99, 0
    s_and_b32 s62, s62, 7
    s_mul_i32 s72, s62, 196608
    s_add_u32 s62, s99, 1
    s_and_b32 s62, s62, 7
    s_mul_i32 s73, s62, 196608
    s_add_u32 s62, s99, 2
    s_and_b32 s62, s62, 7
    s_mul_i32 s74, s62, 196608
    s_add_u32 s62, s99, 3
    s_and_b32 s62, s62, 7
    s_mul_i32 s75, s62, 196608
    s_add_u32 s62, s99, 4
    s_and_b32 s62, s62, 7
    s_mul_i32 s76, s62, 196608
    s_add_u32 s62, s99, 5
    s_and_b32 s62, s62, 7
    s_mul_i32 s77, s62, 196608
    s_add_u32 s62, s99, 6
    s_and_b32 s62, s62, 7
    s_mul_i32 s78, s62, 196608
    s_add_u32 s62, s99, 7
    s_and_b32 s62, s62, 7
    s_mul_i32 s79, s62, 196608
    v_lshrrev_b32 v18, 3, v0
    s_lshl_b32 s62, s56, 4
    v_add_u32 v19, s62, v18
    v_mul_u32_u24 v19, 3072, v19
    v_bfe_u32 v20, v0, 1, 2
    v_bfe_u32 v21, v0, 4, 1
    v_xor_b32 v20, v20, v21
    v_lshlrev_b32 v20, 5, v20
    v_and_b32 v21, 1, v0
    v_lshlrev_b32 v21, 4, v21
    v_add3_u32 v19, v19, v20, v21
    s_lshl_b32 s63, s58, 7
    v_add_u32 v6, s63, v19
    v_xor_b32 v7, 64, v6
    v_add_u32 v7, 24576, v7
    s_lshl_b32 s66, s56, 11
    s_add_u32 s66, s66, 81920
    s_lshl_b32 s63, s70, 2
    v_lshrrev_b32 v19, 4, v0
    v_add_u32 v19, s63, v19
    v_and_b32 v20, 7, v0
    v_xor_b32 v19, v19, v20
    v_lshlrev_b32 v19, 4, v19
    v_lshl_add_u32 v19, v18, 10, v19
    s_lshl_b32 s63, s59, 6
    s_lshl_b32 s64, s56, 3
    s_add_u32 s64, s63, s64
    s_sub_i32 s65, s64, 16
    s_max_i32 s65, s65, 0
    s_lshl_b32 s65, s65, 10
    v_add_u32 v8, s65, v19
    s_add_u32 s65, s64, 16
    s_lshl_b32 s65, s65, 10
    v_add_u32 v9, s65, v19
    s_lshl_b32 s64, s70, 3
    s_add_u32 s65, s63, s64
    s_add_u32 s65, s65, 48
    s_lshl_b32 s65, s65, 10
    v_add_u32 v10, s65, v19
    s_lshl_b32 s67, s56, 10
    s_mul_i32 s68, s69, 10240
    s_lshl_b32 s64, s70, 10
    s_add_u32 s68, s68, s64
    s_add_u32 s68, s68, 8192
    v_and_b32 v18, 15, v0
    v_lshrrev_b32 v19, 4, v0
    v_lshrrev_b32 v20, 1, v18
    v_xor_b32 v20, v20, v19
    v_lshlrev_b32 v20, 4, v20
    v_lshl_add_u32 v11, v18, 7, v20
    v_xor_b32 v12, 64, v11
    s_add_u32 s64, s56, 1
    s_lshl_b32 s64, s64, 11
    v_add_u32 v13, s64, v11
    v_add_u32 v14, s64, v12
    s_lshl_b32 s64, s70, 6
    v_xor_b32 v15, s64, v11
    s_mul_i32 s64, s69, 10240
    v_add_u32 v15, s64, v15
    v_lshrrev_b32 v20, 2, v18
    v_lshl_add_u32 v20, v19, 3, v20
    v_lshlrev_b32 v20, 7, v20
    v_bfe_u32 v21, v0, 3, 1
    v_bfe_u32 v22, v0, 4, 1
    v_lshl_add_u32 v21, v22, 1, v21
    v_xor_b32 v21, s56, v21
    v_lshl_add_u32 v20, v21, 5, v20
    v_and_b32 v21, 3, v0
    v_lshl_add_u32 v20, v21, 3, v20
    v_add_u32 v16, 81920, v20
    v_add_u32 v17, 49152, v16
    s_lshr_b32 s65, s58, 1
    s_mov_b32 s64, 0
    s_mul_i32 s65, s64, 20480
    s_add_u32 s80, s67, s65
    s_add_u32 s81, s68, s65
    s_lshl_b32 s64, s64, 1
    s_add_u32 s64, s64, s99
    s_and_b32 s65, s64, 7
    s_lshl_b32 s82, s65, 7
    s_add_u32 s64, s64, 1
    s_and_b32 s65, s64, 7
    s_lshl_b32 s83, s65, 7
    s_cmp_eq_u32 s69, 0
    s_cselect_b32 s84, s82, s83
    s_lshr_b32 s65, s58, 1
    s_max_u32 s64, s65, 1
    s_mul_i32 s65, s64, 20480
    s_add_u32 s85, s67, s65
    s_add_u32 s86, s68, s65
    s_lshl_b32 s64, s64, 1
    s_add_u32 s64, s64, s99
    s_and_b32 s65, s64, 7
    s_lshl_b32 s87, s65, 7
    s_add_u32 s64, s64, 1
    s_and_b32 s65, s64, 7
    s_lshl_b32 s88, s65, 7
    s_cmp_eq_u32 s69, 0
    s_cselect_b32 s89, s87, s88
    s_lshr_b32 s65, s58, 1
    s_cmp_le_u32 s65, 1
    s_cselect_b32 s64, 2, 1
    s_mul_i32 s65, s64, 20480
    s_add_u32 s90, s67, s65
    s_add_u32 s91, s68, s65
    s_lshl_b32 s64, s64, 1
    s_add_u32 s64, s64, s99
    s_and_b32 s65, s64, 7
    s_lshl_b32 s92, s65, 7
    s_add_u32 s64, s64, 1
    s_and_b32 s65, s64, 7
    s_lshl_b32 s93, s65, 7
    s_cmp_eq_u32 s69, 0
    s_cselect_b32 s94, s92, s93
    s_waitcnt lgkmcnt(0)
    s_mov_b32 s28, s4
    s_and_b32 s29, s5, 0xffff
    s_mov_b32 s30, 2097152
    s_mov_b32 s31, 0x00020000
    s_mov_b32 s32, s6
    s_and_b32 s33, s7, 0xffff
    s_mov_b32 s34, 1572864
    s_mov_b32 s35, 0x00020000
    s_add_u32 m0, s80, 0
    s_mov_b32 s48, s24
    buffer_load_dwordx4 v8, s[28:31], s82 offen lds
    s_and_b32 s49, s25, 0xffff
    s_mov_b32 s50, 27262976
    s_mov_b32 s51, 0x00020000
    s_mov_b32 s36, s8
    s_and_b32 s37, s9, 0xffff
    s_mov_b32 s38, 524288
    s_mov_b32 s39, 0x00020000
    s_mov_b32 s40, s12
    s_and_b32 s41, s13, 0xffff
    s_add_u32 m0, s80, 4096
    s_mov_b32 s42, 1835008
    buffer_load_dwordx4 v9, s[28:31], s82 offen lds
    s_mov_b32 s43, 0x00020000
    s_mov_b32 s44, s16
    s_and_b32 s45, s17, 0xffff
    s_mov_b32 s46, 1835008
    s_mov_b32 s47, 0x00020000
    s_mov_b32 s52, s20
    s_and_b32 s53, s21, 0xffff
    s_mov_b32 s54, 2097152
    s_mov_b32 s55, 0x00020000
    s_add_u32 m0, s80, 10240
    s_lshr_b32 s4, s60, 3
    buffer_load_dwordx4 v8, s[28:31], s83 offen lds
    s_mul_i32 s4, s4, 7
    s_add_u32 s71, s4, s58
    s_add_u32 s4, s58, 4
    s_lshr_b32 s4, s4, 3
    s_sub_u32 s71, s71, s4
    s_and_b32 s26, s71, 1
    s_lshl_b32 s26, s26, 7
    s_xor_b32 s27, s26, 128
    s_mov_b32 s10, 4096
    s_add_u32 m0, s80, 14336
    s_mov_b32 s11, 8192
    buffer_load_dwordx4 v9, s[28:31], s83 offen lds
    s_mov_b32 s12, 12288
    s_mov_b32 s96, 65536
    s_lshl_b32 s13, s69, 8
    s_mul_i32 s4, s70, 48
    s_add_u32 s13, s13, s4
    s_lshl_b32 s13, s13, 10
    s_lshl_b32 s17, s69, 8
    s_lshl_b32 s4, s70, 5
    s_add_u32 s17, s17, s4
    s_mov_b32 m0, s81
    s_add_u32 s17, s17, 192
    buffer_load_dwordx4 v10, s[28:31], s84 offen lds
    s_lshl_b32 s17, s17, 10
    s_mul_i32 s24, s56, 6144
    s_add_u32 s24, s24, 131072
    s_lshl_b32 s25, s56, 12
    s_add_u32 s25, s25, 106496
    s_mul_i32 s20, s56, 7168
    s_add_u32 s20, s20, 131072
    s_lshl_b32 s21, s56, 14
    s_add_u32 s22, s21, 65536
    s_add_u32 m0, s66, 0
    s_mul_i32 s23, s56, 458752
    buffer_load_dwordx4 v6, s[32:35], s72 offen lds
    v_and_b32 v26, 7, v0
    v_lshrrev_b32 v27, 2, v26
    v_bfe_u32 v28, v0, 4, 1
    v_xor_b32 v27, v27, v28
    v_and_b32 v26, 3, v26
    v_lshl_add_u32 v26, v27, 2, v26
    v_lshlrev_b32 v26, 4, v26
    v_lshrrev_b32 v27, 3, v0
    v_lshl_add_u32 v28, v27, 10, v26
    s_add_u32 m0, s66, 1024
    s_lshl_b32 s4, s58, 7
    buffer_load_dwordx4 v7, s[32:35], s72 offen lds
    v_add_u32 v22, s4, v28
    v_mul_u32_u24 v27, 3584, v27
    v_add_u32 v27, v27, v26
    s_mul_i32 s4, s56, 458752
    s_lshl_b32 s5, s71, 8
    s_add_u32 s4, s4, s5
    v_add_u32 v18, s4, v27
    v_add_u32 v19, 27648, v18
    v_add_u32 v23, 7168, v22
    s_add_u32 m0, s66, 7168
    v_add_u32 v20, 55296, v18
    buffer_load_dwordx4 v6, s[32:35], s72 offen offset:1024 lds
    v_add_u32 v24, 14336, v22
    v_add_u32 v21, 82944, v18
    v_add_u32 v25, 21504, v22
    s_lshl_b32 s4, s61, 10
    s_add_u32 s4, s4, 9437184
    v_and_b32 v26, 15, v0
    v_lshlrev_b32 v26, 3, v26
    v_add_u32 v29, s4, v26
    s_lshl_b32 s5, s60, 3
    s_add_u32 m0, s66, 8192
    s_add_u32 s5, s5, s4
    buffer_load_dwordx4 v7, s[32:35], s72 offen offset:1024 lds
    v_mov_b32 v30, s5
    v_mov_b32 v31, s4
    v_min_u32 v34, 2, v0
    v_lshlrev_b32 v34, 7, v34
    v_add_u32 v34, s4, v34
    s_lshl_b32 s4, s2, 2
    s_add_u32 s4, s4, s56
    v_lshlrev_b32 v49, 4, v0
    s_mul_i32 s5, s4, 1792
    s_add_u32 m0, s66, 14336
    v_add_u32 v48, s5, v49
    buffer_load_dwordx4 v6, s[32:35], s72 offen offset:2048 lds
    s_lshl_b32 s5, s4, 9
    v_add_u32 v35, s5, v49
    v_mov_b32 v28, 0x7ffffff0
    v_cmp_gt_u32 vcc, 32, v0
    v_add_u32 v49, 1024, v48
    s_nop 0
    v_cndmask_b32 v35, v28, v35, vcc
    v_cmp_gt_u32 vcc, 48, v0
    s_nop 1
    s_add_u32 m0, s66, 15360
    v_cndmask_b32 v49, v28, v49, vcc
    buffer_load_dwordx4 v7, s[32:35], s72 offen offset:2048 lds
    v_and_b32 v50, 31, v0
    v_lshlrev_b32 v50, 1, v50
    s_lshl_b32 s4, s71, 8
    v_add_u32 v50, s4, v50
    v_add_u32 v51, s27, v50
    v_add_u32 v50, s26, v50
    v_lshrrev_b32 v52, 5, v0
    v_lshlrev_b32 v52, 3, v52
    s_lshl_b32 s4, s58, 7
    s_add_u32 m0, s85, 0
    s_lshl_b32 s5, s69, 6
    buffer_load_dwordx4 v8, s[28:31], s87 offen lds
    s_add_u32 s4, s4, s5
    v_add_u32 v52, s4, v52
    v_mov_b32 v53, 0xff800000
    v_and_b32 v26, 1, v0
    v_cmp_eq_u32 vcc, 1, v26
    v_mov_b32 v54, 0x0c0c0100
    v_mov_b32 v27, 0x01000c0c
    v_cndmask_b32 v54, v54, v27, vcc
    v_mov_b32 v55, 0x0c0c0302
    s_add_u32 m0, s85, 4096
    v_mov_b32 v27, 0x03020c0c
    buffer_load_dwordx4 v9, s[28:31], s87 offen lds
    v_cndmask_b32 v55, v55, v27, vcc
    v_mov_b32 v28, 0
    s_mov_b32 vcc_lo, 0x50000
    s_mov_b32 vcc_hi, 0x5550055
    v_cndmask_b32 v68, v53, v28, vcc
    s_mov_b32 vcc_lo, 0x55505555
    s_mov_b32 vcc_hi, 0x50005500
    v_cndmask_b32 v72, v53, v28, vcc
    s_mov_b32 vcc_lo, 0xa0000
    s_add_u32 m0, s85, 10240
    s_mov_b32 vcc_hi, 0xaaa00aa
    buffer_load_dwordx4 v8, s[28:31], s88 offen lds
    v_cndmask_b32 v69, v53, v28, vcc
    s_mov_b32 vcc_lo, 0xaaa0aaaa
    s_mov_b32 vcc_hi, 0xa000aa00
    v_cndmask_b32 v73, v53, v28, vcc
    s_mov_b32 vcc_lo, 0x150001
    s_mov_b32 vcc_hi, 0x15550155
    v_cndmask_b32 v70, v53, v28, vcc
    s_mov_b32 vcc_lo, 0x55405554
    s_mov_b32 vcc_hi, 0x40005400
    s_add_u32 m0, s85, 14336
    v_cndmask_b32 v74, v53, v28, vcc
    buffer_load_dwordx4 v9, s[28:31], s88 offen lds
    s_mov_b32 vcc_lo, 0x2a0002
    s_mov_b32 vcc_hi, 0x2aaa02aa
    v_cndmask_b32 v71, v53, v28, vcc
    s_mov_b32 vcc_lo, 0xaa80aaa8
    s_mov_b32 vcc_hi, 0x8000a800
    v_cndmask_b32 v75, v53, v28, vcc
    s_cmp_eq_u32 s59, 0
    s_cselect_b64 vcc, -1, 0
    v_cndmask_b32 v76, v68, v53, vcc
    s_mov_b32 m0, s86
    v_cndmask_b32 v77, v69, v53, vcc
    buffer_load_dwordx4 v10, s[28:31], s89 offen lds
    v_cndmask_b32 v78, v70, v53, vcc
    v_cndmask_b32 v79, v71, v53, vcc
    v_mov_b32 v56, 0x3b000000
    v_mov_b32 v62, 0x3e003e00
    v_mov_b32 v63, 0x3e003e00
    v_and_b32 v59, 15, v0
    v_lshlrev_b32 v59, 3, v59
    v_add_u32 v59, 159744, v59
    s_add_u32 s4, s56, 1
    s_add_u32 m0, s66, 24576
    s_lshl_b32 s4, s4, 7
    buffer_load_dwordx4 v6, s[32:35], s73 offen lds
    v_add_u32 v57, s4, v59
    s_lshl_b32 s4, s56, 7
    s_add_u32 s4, s4, 1024
    v_add_u32 v58, s4, v59
    v_bfe_u32 v26, v0, 2, 2
    v_lshrrev_b32 v27, 4, v0
    v_cmp_eq_u32 vcc, v26, v27
    v_lshlrev_b32 v26, 3, v0
    v_add_u32 v26, 161792, v26
    s_add_u32 m0, s66, 25600
    v_cndmask_b32 v57, v26, v57, vcc
    buffer_load_dwordx4 v7, s[32:35], s73 offen lds
    v_cndmask_b32 v58, v26, v58, vcc
    v_and_b32 v26, 15, v0
    v_bfe_u32 v27, v0, 5, 1
    v_mul_u32_u24 v27, 640, v27
    v_lshl_add_u32 v27, v26, 4, v27
    v_bfe_u32 v28, v0, 4, 1
    v_lshl_add_u32 v27, v28, 3, v27
    s_lshl_b32 s4, s58, 2
    s_add_u32 s4, s4, s56
    s_add_u32 m0, s66, 31744
    s_lshl_b32 s4, s4, 11
    buffer_load_dwordx4 v6, s[32:35], s73 offen offset:1024 lds
    s_lshl_b32 s5, s59, 17
    s_add_u32 s4, s4, s5
    v_add_u32 v60, s4, v27
    v_bfe_u32 v26, v0, 3, 1
    v_bfe_u32 v28, v0, 5, 1
    v_xor_b32 v28, 1, v28
    v_and_b32 v26, v26, v28
    v_lshlrev_b32 v26, 7, v26
    v_add_u32 v26, 256, v26
    s_add_u32 m0, s66, 32768
    v_add_u32 v61, v60, v26
    buffer_load_dwordx4 v7, s[32:35], s73 offen offset:1024 lds
    s_lshl_b32 s4, s70, 5
    s_add_u32 s4, s4, 16
    v_and_b32 v26, 31, v0
    v_add_u32 v26, s4, v26
    v_bfe_u32 v27, v26, 1, 3
    s_lshl_b32 s5, s69, 2
    v_xor_b32 v27, s5, v27
    s_sub_u32 s6, s58, s99
    s_and_b32 s6, s6, 7
    s_add_u32 m0, s66, 38912
    s_mul_i32 s6, s6, 10240
    buffer_load_dwordx4 v6, s[32:35], s73 offen offset:2048 lds
    v_lshrrev_b32 v28, 5, v0
    v_lshlrev_b32 v28, 3, v28
    v_lshl_add_u32 v28, v26, 7, v28
    v_add_u32 v28, s6, v28
    v_xor_b32 v26, 0, v27
    v_lshl_add_u32 v64, v26, 4, v28
    v_xor_b32 v26, 1, v27
    v_lshl_add_u32 v65, v26, 4, v28
    v_xor_b32 v26, 2, v27
    s_add_u32 m0, s66, 39936
    v_lshl_add_u32 v66, v26, 4, v28
    buffer_load_dwordx4 v7, s[32:35], s73 offen offset:2048 lds
    v_xor_b32 v26, 3, v27
    v_lshl_add_u32 v67, v26, 4, v28
    v_mov_b32 v2, 0x3f803f80
    v_mov_b32 v3, 0x3f803f80
    v_mov_b32 v4, 0x3f803f80
    v_mov_b32 v5, 0x3f803f80
    s_waitcnt vmcnt(11)
    s_barrier
    ds_read_b64_tr_b16 a[24:25], v16 offset:8192
    ds_read_b64_tr_b16 a[26:27], v16 offset:8704
    ds_read_b128 a[0:3], v11 offset:0
    ds_read_b128 a[4:7], v11 offset:2048
    ds_read_b128 a[8:11], v11 offset:4096
    ds_read_b128 a[12:15], v11 offset:6144
    ds_read_b128 a[16:19], v11 offset:8192
    ds_read_b64_tr_b16 a[28:29], v16 offset:16384
    ds_read_b64_tr_b16 a[30:31], v16 offset:16896
    ds_read_b64_tr_b16 a[20:21], v16 offset:0
    ds_read_b64_tr_b16 a[22:23], v16 offset:512
    ds_read_b128 a[64:67], v13 offset:0
    s_waitcnt lgkmcnt(0)
    v_mfma_f32_16x16x32_bf16 v[96:99], a[24:27], a[0:3], 0
    ds_read_b64_tr_b16 a[56:57], v16 offset:12288
    s_add_u32 m0, s90, 0
    v_mfma_f32_16x16x32_bf16 v[100:103], a[24:27], a[4:7], 0
    buffer_load_dwordx4 v8, s[28:31], s92 offen lds
    ds_read_b64_tr_b16 a[58:59], v16 offset:12800
    s_add_u32 m0, s90, 4096
    v_mfma_f32_16x16x32_bf16 v[104:107], a[24:27], a[8:11], 0
    buffer_load_dwordx4 v9, s[28:31], s92 offen lds
    ds_read_b128 a[32:35], v12 offset:0
    v_mfma_f32_16x16x32_bf16 v[108:111], a[24:27], a[12:15], 0
    ds_read_b128 a[36:39], v12 offset:2048
    s_add_u32 m0, s90, 10240
    v_mfma_f32_16x16x32_bf16 v[112:115], a[24:27], a[16:19], 0
    buffer_load_dwordx4 v8, s[28:31], s93 offen lds
    ds_read_b128 a[40:43], v12 offset:4096
    s_add_u32 m0, s90, 14336
    v_mfma_f32_16x16x32_bf16 v[140:143], v[2:5], a[24:27], 0
    buffer_load_dwordx4 v9, s[28:31], s93 offen lds
    ds_read_b128 a[44:47], v12 offset:6144
    v_mfma_f32_16x16x32_bf16 v[148:151], v[2:5], a[64:67], 0
    ds_read_b128 a[48:51], v12 offset:8192
    s_mov_b32 m0, s91
    v_mfma_f32_16x16x32_bf16 v[152:155], a[64:67], a[64:67], 0
    buffer_load_dwordx4 v10, s[28:31], s94 offen lds
    ds_read_b64_tr_b16 a[60:61], v16 offset:20480
    s_add_u32 m0, s66, 49152
    v_mfma_f32_16x16x32_bf16 v[116:119], a[0:3], a[28:31], 0
    buffer_load_dwordx4 v6, s[32:35], s74 offen lds
    ds_read_b64_tr_b16 a[62:63], v16 offset:20992
    v_mfma_f32_16x16x32_bf16 v[120:123], a[4:7], a[28:31], 0
    ds_read_b64_tr_b16 a[52:53], v16 offset:4096
    s_add_u32 m0, s66, 50176
    v_mfma_f32_16x16x32_bf16 v[124:127], a[8:11], a[28:31], 0
    buffer_load_dwordx4 v7, s[32:35], s74 offen lds
    ds_read_b64_tr_b16 a[54:55], v16 offset:4608
    s_add_u32 m0, s66, 56320
    v_mfma_f32_16x16x32_bf16 v[128:131], a[12:15], a[28:31], 0
    buffer_load_dwordx4 v6, s[32:35], s74 offen offset:1024 lds
    ds_read_b128 a[72:75], v14 offset:0
    v_mfma_f32_16x16x32_bf16 v[132:135], a[16:19], a[28:31], 0
    s_add_u32 m0, s66, 57344
    v_mfma_f32_16x16x32_bf16 v[144:147], v[2:5], a[28:31], 0
    buffer_load_dwordx4 v7, s[32:35], s74 offen offset:1024 lds
    s_add_u32 m0, s66, 63488
    v_mfma_f32_16x16x32_bf16 v[80:83], a[20:23], a[4:7], 0
    buffer_load_dwordx4 v6, s[32:35], s74 offen offset:2048 lds
    v_mfma_f32_16x16x32_bf16 v[84:87], a[20:23], a[8:11], 0
    s_add_u32 m0, s66, 64512
    v_mfma_f32_16x16x32_bf16 v[88:91], a[20:23], a[12:15], 0
    buffer_load_dwordx4 v7, s[32:35], s74 offen offset:2048 lds
    v_mfma_f32_16x16x32_bf16 v[92:95], a[20:23], a[16:19], 0
    v_mfma_f32_16x16x32_bf16 v[136:139], v[2:5], a[20:23], 0
    s_waitcnt lgkmcnt(0)
    s_waitcnt vmcnt(11)
    s_barrier
    v_mfma_f32_16x16x32_bf16 v[96:99], a[56:59], a[32:35], v[96:99]
    ds_read_b64_tr_b16 a[24:25], v16 offset:32768
    s_add_u32 m0, s66, 0
    v_mfma_f32_16x16x32_bf16 v[100:103], a[56:59], a[36:39], v[100:103]
    buffer_load_dwordx4 v6, s[32:35], s75 offen lds
    ds_read_b64_tr_b16 a[26:27], v16 offset:33280
    v_mfma_f32_16x16x32_bf16 v[104:107], a[56:59], a[40:43], v[104:107]
    ds_read_b128 a[0:3], v11 offset:10240
    s_add_u32 m0, s66, 1024
    v_mfma_f32_16x16x32_bf16 v[108:111], a[56:59], a[44:47], v[108:111]
    buffer_load_dwordx4 v7, s[32:35], s75 offen lds
    ds_read_b128 a[4:7], v11 offset:12288
    v_mfma_f32_16x16x32_bf16 v[112:115], a[56:59], a[48:51], v[112:115]
    ds_read_b128 a[8:11], v11 offset:14336
    s_lshr_b32 s65, s58, 1
    v_mfma_f32_16x16x32_bf16 v[140:143], v[2:5], a[56:59], v[140:143]
    ds_read_b128 a[12:15], v11 offset:16384
    s_add_u32 m0, s66, 7168
    v_mfma_f32_16x16x32_bf16 v[148:151], v[2:5], a[72:75], v[148:151]
    buffer_load_dwordx4 v6, s[32:35], s75 offen offset:1024 lds
    ds_read_b128 a[16:19], v11 offset:18432
    v_mfma_f32_16x16x32_bf16 v[152:155], a[72:75], a[72:75], v[152:155]
    ds_read_b64_tr_b16 a[28:29], v16 offset:40960
    s_cmp_eq_u32 s65, 3
    s_cselect_b32 s64, 2, 3
    v_mfma_f32_16x16x32_bf16 v[116:119], a[32:35], a[60:63], v[116:119]
    ds_read_b64_tr_b16 a[30:31], v16 offset:41472
    s_add_u32 m0, s66, 8192
    v_mfma_f32_16x16x32_bf16 v[120:123], a[36:39], a[60:63], v[120:123]
    buffer_load_dwordx4 v7, s[32:35], s75 offen offset:1024 lds
    ds_read_b64_tr_b16 a[20:21], v16 offset:24576
    v_mfma_f32_16x16x32_bf16 v[124:127], a[40:43], a[60:63], v[124:127]
    ds_read_b64_tr_b16 a[22:23], v16 offset:25088
    s_mul_i32 s65, s64, 20480
    v_mfma_f32_16x16x32_bf16 v[128:131], a[44:47], a[60:63], v[128:131]
    ds_read_b128 a[64:67], v13 offset:10240
    s_add_u32 m0, s66, 14336
    v_mfma_f32_16x16x32_bf16 v[132:135], a[48:51], a[60:63], v[132:135]
    buffer_load_dwordx4 v6, s[32:35], s75 offen offset:2048 lds
    s_add_u32 s80, s67, s65
    v_mfma_f32_16x16x32_bf16 v[144:147], v[2:5], a[60:63], v[144:147]
    s_add_u32 s81, s68, s65
    s_lshl_b32 s64, s64, 1
    v_mfma_f32_16x16x32_bf16 v[80:83], a[52:55], a[36:39], v[80:83]
    s_add_u32 m0, s66, 15360
    s_add_u32 s64, s64, s99
    v_mfma_f32_16x16x32_bf16 v[84:87], a[52:55], a[40:43], v[84:87]
    buffer_load_dwordx4 v7, s[32:35], s75 offen offset:2048 lds
    s_and_b32 s65, s64, 7
    v_mfma_f32_16x16x32_bf16 v[88:91], a[52:55], a[44:47], v[88:91]
    s_lshl_b32 s82, s65, 7
    s_add_u32 s64, s64, 1
    v_mfma_f32_16x16x32_bf16 v[92:95], a[52:55], a[48:51], v[92:95]
    s_and_b32 s65, s64, 7
    s_lshl_b32 s83, s65, 7
    v_mfma_f32_16x16x32_bf16 v[136:139], v[2:5], a[52:55], v[136:139]
    s_cmp_eq_u32 s69, 0
    s_cselect_b32 s84, s82, s83
    s_waitcnt lgkmcnt(0)
    v_mfma_f32_16x16x32_bf16 v[96:99], a[24:27], a[0:3], v[96:99]
    ds_read_b64_tr_b16 a[56:57], v16 offset:36864
    s_add_u32 m0, s80, 0
    v_mfma_f32_16x16x32_bf16 v[100:103], a[24:27], a[4:7], v[100:103]
    buffer_load_dwordx4 v8, s[28:31], s82 offen lds
    ds_read_b64_tr_b16 a[58:59], v16 offset:37376
    v_mfma_f32_16x16x32_bf16 v[104:107], a[24:27], a[8:11], v[104:107]
    ds_read_b128 a[32:35], v12 offset:10240
    v_mfma_f32_16x16x32_bf16 v[108:111], a[24:27], a[12:15], v[108:111]
    ds_read_b128 a[36:39], v12 offset:12288
    s_add_u32 m0, s80, 4096
    v_mfma_f32_16x16x32_bf16 v[112:115], a[24:27], a[16:19], v[112:115]
    buffer_load_dwordx4 v9, s[28:31], s82 offen lds
    ds_read_b128 a[40:43], v12 offset:14336
    v_mfma_f32_16x16x32_bf16 v[140:143], v[2:5], a[24:27], v[140:143]
    ds_read_b128 a[44:47], v12 offset:16384
    v_mfma_f32_16x16x32_bf16 v[148:151], v[2:5], a[64:67], v[148:151]
    ds_read_b128 a[48:51], v12 offset:18432
    s_add_u32 m0, s80, 10240
    v_mfma_f32_16x16x32_bf16 v[152:155], a[64:67], a[64:67], v[152:155]
    buffer_load_dwordx4 v8, s[28:31], s83 offen lds
    ds_read_b64_tr_b16 a[60:61], v16 offset:45056
    v_mfma_f32_16x16x32_bf16 v[116:119], a[0:3], a[28:31], v[116:119]
    ds_read_b64_tr_b16 a[62:63], v16 offset:45568
    v_mfma_f32_16x16x32_bf16 v[120:123], a[4:7], a[28:31], v[120:123]
    ds_read_b64_tr_b16 a[52:53], v16 offset:28672
    v_mfma_f32_16x16x32_bf16 v[124:127], a[8:11], a[28:31], v[124:127]
    ds_read_b64_tr_b16 a[54:55], v16 offset:29184
    s_add_u32 m0, s80, 14336
    v_mfma_f32_16x16x32_bf16 v[128:131], a[12:15], a[28:31], v[128:131]
    buffer_load_dwordx4 v9, s[28:31], s83 offen lds
    ds_read_b128 a[72:75], v14 offset:10240
    v_mfma_f32_16x16x32_bf16 v[132:135], a[16:19], a[28:31], v[132:135]
    ds_read_b128 a[80:83], v15 offset:0
    v_mfma_f32_16x16x32_bf16 v[144:147], v[2:5], a[28:31], v[144:147]
    s_mov_b32 m0, s81
    v_mfma_f32_16x16x32_bf16 v[80:83], a[20:23], a[4:7], v[80:83]
    buffer_load_dwordx4 v10, s[28:31], s84 offen lds
    v_mfma_f32_16x16x32_bf16 v[84:87], a[20:23], a[8:11], v[84:87]
    v_mfma_f32_16x16x32_bf16 v[88:91], a[20:23], a[12:15], v[88:91]
    v_mfma_f32_16x16x32_bf16 v[92:95], a[20:23], a[16:19], v[92:95]
    v_mfma_f32_16x16x32_bf16 v[136:139], v[2:5], a[20:23], v[136:139]
    s_waitcnt lgkmcnt(0)
    s_waitcnt vmcnt(11)
    s_barrier
    v_mfma_f32_16x16x32_bf16 v[96:99], a[56:59], a[32:35], v[96:99]
    ds_read_b64_tr_b16 a[24:25], v17 offset:8192
    s_add_u32 m0, s66, 24576
    v_mfma_f32_16x16x32_bf16 v[100:103], a[56:59], a[36:39], v[100:103]
    buffer_load_dwordx4 v6, s[32:35], s76 offen lds
    ds_read_b64_tr_b16 a[26:27], v17 offset:8704
    v_mfma_f32_16x16x32_bf16 v[104:107], a[56:59], a[40:43], v[104:107]
    ds_read_b128 a[0:3], v11 offset:20480
    v_mfma_f32_16x16x32_bf16 v[108:111], a[56:59], a[44:47], v[108:111]
    ds_read_b128 a[4:7], v11 offset:22528
    s_add_u32 m0, s66, 25600
    v_mfma_f32_16x16x32_bf16 v[112:115], a[56:59], a[48:51], v[112:115]
    buffer_load_dwordx4 v7, s[32:35], s76 offen lds
    ds_read_b128 a[8:11], v11 offset:24576
    v_mfma_f32_16x16x32_bf16 v[140:143], v[2:5], a[56:59], v[140:143]
    ds_read_b128 a[12:15], v11 offset:26624
    v_mfma_f32_16x16x32_bf16 v[148:151], v[2:5], a[72:75], v[148:151]
    ds_read_b128 a[16:19], v11 offset:28672
    s_add_u32 m0, s66, 31744
    v_mfma_f32_16x16x32_bf16 v[152:155], a[72:75], a[72:75], v[152:155]
    buffer_load_dwordx4 v6, s[32:35], s76 offen offset:1024 lds
    ds_read_b64_tr_b16 a[28:29], v17 offset:16384
    v_mfma_f32_16x16x32_bf16 v[156:159], v[2:5], a[80:83], 0
    ds_read_b64_tr_b16 a[30:31], v17 offset:16896
    v_mfma_f32_16x16x32_bf16 v[160:163], a[80:83], a[80:83], 0
    ds_read_b64_tr_b16 a[20:21], v17 offset:0
    s_add_u32 m0, s66, 32768
    v_mfma_f32_16x16x32_bf16 v[116:119], a[32:35], a[60:63], v[116:119]
    buffer_load_dwordx4 v7, s[32:35], s76 offen offset:1024 lds
    ds_read_b64_tr_b16 a[22:23], v17 offset:512
    v_mfma_f32_16x16x32_bf16 v[120:123], a[36:39], a[60:63], v[120:123]
    ds_read_b128 a[64:67], v13 offset:20480
    v_mfma_f32_16x16x32_bf16 v[124:127], a[40:43], a[60:63], v[124:127]
    s_add_u32 m0, s66, 38912
    v_mfma_f32_16x16x32_bf16 v[128:131], a[44:47], a[60:63], v[128:131]
    buffer_load_dwordx4 v6, s[32:35], s76 offen offset:2048 lds
    v_mfma_f32_16x16x32_bf16 v[132:135], a[48:51], a[60:63], v[132:135]
    v_mfma_f32_16x16x32_bf16 v[144:147], v[2:5], a[60:63], v[144:147]
    s_add_u32 m0, s66, 39936
    v_mfma_f32_16x16x32_bf16 v[80:83], a[52:55], a[36:39], v[80:83]
    buffer_load_dwordx4 v7, s[32:35], s76 offen offset:2048 lds
    v_mfma_f32_16x16x32_bf16 v[84:87], a[52:55], a[40:43], v[84:87]
    v_mfma_f32_16x16x32_bf16 v[88:91], a[52:55], a[44:47], v[88:91]
    v_mfma_f32_16x16x32_bf16 v[92:95], a[52:55], a[48:51], v[92:95]
    v_mfma_f32_16x16x32_bf16 v[136:139], v[2:5], a[52:55], v[136:139]
    s_waitcnt lgkmcnt(0)
    v_mfma_f32_16x16x32_bf16 v[96:99], a[24:27], a[0:3], v[96:99]
    ds_read_b64_tr_b16 a[56:57], v17 offset:12288
    v_mfma_f32_16x16x32_bf16 v[100:103], a[24:27], a[4:7], v[100:103]
    ds_read_b64_tr_b16 a[58:59], v17 offset:12800
    v_mfma_f32_16x16x32_bf16 v[104:107], a[24:27], a[8:11], v[104:107]
    ds_read_b128 a[32:35], v12 offset:20480
    v_mfma_f32_16x16x32_bf16 v[108:111], a[24:27], a[12:15], v[108:111]
    ds_read_b128 a[36:39], v12 offset:22528
    v_mfma_f32_16x16x32_bf16 v[112:115], a[24:27], a[16:19], v[112:115]
    ds_read_b128 a[40:43], v12 offset:24576
    v_mfma_f32_16x16x32_bf16 v[140:143], v[2:5], a[24:27], v[140:143]
    ds_read_b128 a[44:47], v12 offset:26624
    v_mfma_f32_16x16x32_bf16 v[148:151], v[2:5], a[64:67], v[148:151]
    ds_read_b128 a[48:51], v12 offset:28672
    v_mfma_f32_16x16x32_bf16 v[152:155], a[64:67], a[64:67], v[152:155]
    ds_read_b64_tr_b16 a[60:61], v17 offset:20480
    v_mfma_f32_16x16x32_bf16 v[116:119], a[0:3], a[28:31], v[116:119]
    ds_read_b64_tr_b16 a[62:63], v17 offset:20992
    v_mfma_f32_16x16x32_bf16 v[120:123], a[4:7], a[28:31], v[120:123]
    ds_read_b64_tr_b16 a[52:53], v17 offset:4096
    v_mfma_f32_16x16x32_bf16 v[124:127], a[8:11], a[28:31], v[124:127]
    ds_read_b64_tr_b16 a[54:55], v17 offset:4608
    v_mfma_f32_16x16x32_bf16 v[128:131], a[12:15], a[28:31], v[128:131]
    ds_read_b128 a[72:75], v14 offset:20480
    v_mfma_f32_16x16x32_bf16 v[132:135], a[16:19], a[28:31], v[132:135]
    ds_read_b128 a[84:87], v15 offset:20480
    v_mfma_f32_16x16x32_bf16 v[144:147], v[2:5], a[28:31], v[144:147]
    v_mfma_f32_16x16x32_bf16 v[80:83], a[20:23], a[4:7], v[80:83]
    v_mfma_f32_16x16x32_bf16 v[84:87], a[20:23], a[8:11], v[84:87]
    v_mfma_f32_16x16x32_bf16 v[88:91], a[20:23], a[12:15], v[88:91]
    v_mfma_f32_16x16x32_bf16 v[92:95], a[20:23], a[16:19], v[92:95]
    v_mfma_f32_16x16x32_bf16 v[136:139], v[2:5], a[20:23], v[136:139]
    s_waitcnt lgkmcnt(0)
    s_waitcnt vmcnt(11)
    s_barrier
    v_mfma_f32_16x16x32_bf16 v[96:99], a[56:59], a[32:35], v[96:99]
    ds_read_b64_tr_b16 a[24:25], v16 offset:8192
    s_add_u32 m0, s66, 49152
    v_mfma_f32_16x16x32_bf16 v[100:103], a[56:59], a[36:39], v[100:103]
    buffer_load_dwordx4 v6, s[32:35], s77 offen lds
    ds_read_b64_tr_b16 a[26:27], v16 offset:8704
    v_mfma_f32_16x16x32_bf16 v[104:107], a[56:59], a[40:43], v[104:107]
    ds_read_b128 a[0:3], v11 offset:30720
    v_mfma_f32_16x16x32_bf16 v[108:111], a[56:59], a[44:47], v[108:111]
    ds_read_b128 a[4:7], v11 offset:32768
    s_add_u32 m0, s66, 50176
    v_mfma_f32_16x16x32_bf16 v[112:115], a[56:59], a[48:51], v[112:115]
    buffer_load_dwordx4 v7, s[32:35], s77 offen lds
    ds_read_b128 a[8:11], v11 offset:34816
    v_mfma_f32_16x16x32_bf16 v[140:143], v[2:5], a[56:59], v[140:143]
    ds_read_b128 a[12:15], v11 offset:36864
    v_mfma_f32_16x16x32_bf16 v[148:151], v[2:5], a[72:75], v[148:151]
    ds_read_b128 a[16:19], v11 offset:38912
    s_add_u32 m0, s66, 56320
    v_mfma_f32_16x16x32_bf16 v[152:155], a[72:75], a[72:75], v[152:155]
    buffer_load_dwordx4 v6, s[32:35], s77 offen offset:1024 lds
    ds_read_b64_tr_b16 a[28:29], v16 offset:16384
    v_mfma_f32_16x16x32_bf16 v[156:159], v[2:5], a[84:87], v[156:159]
    ds_read_b64_tr_b16 a[30:31], v16 offset:16896
    v_mfma_f32_16x16x32_bf16 v[160:163], a[84:87], a[84:87], v[160:163]
    ds_read_b64_tr_b16 a[20:21], v16 offset:0
    s_add_u32 m0, s66, 57344
    v_mfma_f32_16x16x32_bf16 v[116:119], a[32:35], a[60:63], v[116:119]
    buffer_load_dwordx4 v7, s[32:35], s77 offen offset:1024 lds
    ds_read_b64_tr_b16 a[22:23], v16 offset:512
    v_mfma_f32_16x16x32_bf16 v[120:123], a[36:39], a[60:63], v[120:123]
    ds_read_b128 a[64:67], v13 offset:30720
    v_mfma_f32_16x16x32_bf16 v[124:127], a[40:43], a[60:63], v[124:127]
    s_add_u32 m0, s66, 63488
    v_mfma_f32_16x16x32_bf16 v[128:131], a[44:47], a[60:63], v[128:131]
    buffer_load_dwordx4 v6, s[32:35], s77 offen offset:2048 lds
    v_mfma_f32_16x16x32_bf16 v[132:135], a[48:51], a[60:63], v[132:135]
    v_mfma_f32_16x16x32_bf16 v[144:147], v[2:5], a[60:63], v[144:147]
    s_add_u32 m0, s66, 64512
    v_mfma_f32_16x16x32_bf16 v[80:83], a[52:55], a[36:39], v[80:83]
    buffer_load_dwordx4 v7, s[32:35], s77 offen offset:2048 lds
    v_mfma_f32_16x16x32_bf16 v[84:87], a[52:55], a[40:43], v[84:87]
    v_mfma_f32_16x16x32_bf16 v[88:91], a[52:55], a[44:47], v[88:91]
    v_mfma_f32_16x16x32_bf16 v[92:95], a[52:55], a[48:51], v[92:95]
    buffer_load_dwordx4 v[252:255], v35, s[36:39], 0 offen
    v_mfma_f32_16x16x32_bf16 v[136:139], v[2:5], a[52:55], v[136:139]
    s_waitcnt lgkmcnt(0)
    v_mfma_f32_16x16x32_bf16 v[96:99], a[24:27], a[0:3], v[96:99]
    ds_read_b64_tr_b16 a[56:57], v16 offset:12288
    v_mfma_f32_16x16x32_bf16 v[100:103], a[24:27], a[4:7], v[100:103]
    ds_read_b64_tr_b16 a[58:59], v16 offset:12800
    v_mfma_f32_16x16x32_bf16 v[104:107], a[24:27], a[8:11], v[104:107]
    ds_read_b128 a[32:35], v12 offset:30720
    v_mfma_f32_16x16x32_bf16 v[108:111], a[24:27], a[12:15], v[108:111]
    ds_read_b128 a[36:39], v12 offset:32768
    v_mfma_f32_16x16x32_bf16 v[112:115], a[24:27], a[16:19], v[112:115]
    ds_read_b128 a[40:43], v12 offset:34816
    v_mfma_f32_16x16x32_bf16 v[140:143], v[2:5], a[24:27], v[140:143]
    ds_read_b128 a[44:47], v12 offset:36864
    v_mfma_f32_16x16x32_bf16 v[148:151], v[2:5], a[64:67], v[148:151]
    ds_read_b128 a[48:51], v12 offset:38912
    v_mfma_f32_16x16x32_bf16 v[152:155], a[64:67], a[64:67], v[152:155]
    ds_read_b64_tr_b16 a[60:61], v16 offset:20480
    v_mfma_f32_16x16x32_bf16 v[116:119], a[0:3], a[28:31], v[116:119]
    ds_read_b64_tr_b16 a[62:63], v16 offset:20992
    v_mfma_f32_16x16x32_bf16 v[120:123], a[4:7], a[28:31], v[120:123]
    ds_read_b64_tr_b16 a[52:53], v16 offset:4096
    v_mfma_f32_16x16x32_bf16 v[124:127], a[8:11], a[28:31], v[124:127]
    ds_read_b64_tr_b16 a[54:55], v16 offset:4608
    v_mfma_f32_16x16x32_bf16 v[128:131], a[12:15], a[28:31], v[128:131]
    ds_read_b128 a[72:75], v14 offset:30720
    v_mfma_f32_16x16x32_bf16 v[132:135], a[16:19], a[28:31], v[132:135]
    v_mfma_f32_16x16x32_bf16 v[144:147], v[2:5], a[28:31], v[144:147]
    v_mfma_f32_16x16x32_bf16 v[80:83], a[20:23], a[4:7], v[80:83]
    v_mfma_f32_16x16x32_bf16 v[84:87], a[20:23], a[8:11], v[84:87]
    v_mfma_f32_16x16x32_bf16 v[88:91], a[20:23], a[12:15], v[88:91]
    v_mfma_f32_16x16x32_bf16 v[92:95], a[20:23], a[16:19], v[92:95]
    v_mfma_f32_16x16x32_bf16 v[136:139], v[2:5], a[20:23], v[136:139]
    s_waitcnt lgkmcnt(0)
    s_waitcnt vmcnt(7)
    s_barrier
    v_mfma_f32_16x16x32_bf16 v[96:99], a[56:59], a[32:35], v[96:99]
    ds_read_b64_tr_b16 a[24:25], v16 offset:32768
    s_add_u32 m0, s66, 0
    v_mfma_f32_16x16x32_bf16 v[100:103], a[56:59], a[36:39], v[100:103]
    buffer_load_dwordx4 v6, s[32:35], s78 offen lds
    ds_read_b64_tr_b16 a[26:27], v16 offset:33280
    v_mfma_f32_16x16x32_bf16 v[104:107], a[56:59], a[40:43], v[104:107]
    ds_read_b128 a[0:3], v11 offset:40960
    s_add_u32 m0, s66, 1024
    v_mfma_f32_16x16x32_bf16 v[108:111], a[56:59], a[44:47], v[108:111]
    buffer_load_dwordx4 v7, s[32:35], s78 offen lds
    ds_read_b128 a[4:7], v11 offset:43008
    v_mfma_f32_16x16x32_bf16 v[112:115], a[56:59], a[48:51], v[112:115]
    ds_read_b128 a[8:11], v11 offset:45056
    v_mfma_f32_16x16x32_bf16 v[140:143], v[2:5], a[56:59], v[140:143]
    ds_read_b128 a[12:15], v11 offset:47104
    s_add_u32 m0, s66, 7168
    v_mfma_f32_16x16x32_bf16 v[148:151], v[2:5], a[72:75], v[148:151]
    buffer_load_dwordx4 v6, s[32:35], s78 offen offset:1024 lds
    ds_read_b128 a[16:19], v11 offset:49152
    v_mfma_f32_16x16x32_bf16 v[152:155], a[72:75], a[72:75], v[152:155]
    ds_read_b64_tr_b16 a[28:29], v16 offset:40960
    v_mfma_f32_16x16x32_bf16 v[116:119], a[32:35], a[60:63], v[116:119]
    ds_read_b64_tr_b16 a[30:31], v16 offset:41472
    s_add_u32 m0, s66, 8192
    v_mfma_f32_16x16x32_bf16 v[120:123], a[36:39], a[60:63], v[120:123]
    buffer_load_dwordx4 v7, s[32:35], s78 offen offset:1024 lds
    ds_read_b64_tr_b16 a[20:21], v16 offset:24576
    v_mfma_f32_16x16x32_bf16 v[124:127], a[40:43], a[60:63], v[124:127]
    ds_read_b64_tr_b16 a[22:23], v16 offset:25088
    v_mfma_f32_16x16x32_bf16 v[128:131], a[44:47], a[60:63], v[128:131]
    ds_read_b128 a[64:67], v13 offset:40960
    s_add_u32 m0, s66, 14336
    v_mfma_f32_16x16x32_bf16 v[132:135], a[48:51], a[60:63], v[132:135]
    buffer_load_dwordx4 v6, s[32:35], s78 offen offset:2048 lds
    ds_read_b128 a[68:71], v14 offset:40960
    v_mfma_f32_16x16x32_bf16 v[144:147], v[2:5], a[60:63], v[144:147]
    ds_read_b128 a[80:83], v15 offset:40960
    v_mfma_f32_16x16x32_bf16 v[80:83], a[52:55], a[36:39], v[80:83]
    s_add_u32 m0, s66, 15360
    v_mfma_f32_16x16x32_bf16 v[84:87], a[52:55], a[40:43], v[84:87]
    buffer_load_dwordx4 v7, s[32:35], s78 offen offset:2048 lds
    v_mfma_f32_16x16x32_bf16 v[88:91], a[52:55], a[44:47], v[88:91]
    v_mfma_f32_16x16x32_bf16 v[92:95], a[52:55], a[48:51], v[92:95]
    v_mfma_f32_16x16x32_bf16 v[136:139], v[2:5], a[52:55], v[136:139]
    s_waitcnt lgkmcnt(0)
    v_mfma_f32_16x16x32_bf16 v[96:99], a[24:27], a[0:3], v[96:99]
    ds_read_b64_tr_b16 a[56:57], v16 offset:36864
    v_mfma_f32_16x16x32_bf16 v[100:103], a[24:27], a[4:7], v[100:103]
    ds_read_b64_tr_b16 a[58:59], v16 offset:37376
    v_mfma_f32_16x16x32_bf16 v[104:107], a[24:27], a[8:11], v[104:107]
    ds_read_b128 a[32:35], v12 offset:40960
    v_mfma_f32_16x16x32_bf16 v[108:111], a[24:27], a[12:15], v[108:111]
    ds_read_b128 a[36:39], v12 offset:43008
    v_mfma_f32_16x16x32_bf16 v[112:115], a[24:27], a[16:19], v[112:115]
    ds_read_b128 a[40:43], v12 offset:45056
    v_mfma_f32_16x16x32_bf16 v[140:143], v[2:5], a[24:27], v[140:143]
    ds_read_b128 a[44:47], v12 offset:47104
    v_mfma_f32_16x16x32_bf16 v[148:151], v[2:5], a[64:67], v[148:151]
    ds_read_b128 a[48:51], v12 offset:49152
    v_mfma_f32_16x16x32_bf16 v[152:155], a[64:67], a[64:67], v[152:155]
    ds_read_b64_tr_b16 a[60:61], v16 offset:45056
    v_mfma_f32_16x16x32_bf16 v[148:151], v[2:5], a[68:71], v[148:151]
    ds_read_b64_tr_b16 a[62:63], v16 offset:45568
    v_mfma_f32_16x16x32_bf16 v[152:155], a[68:71], a[68:71], v[152:155]
    ds_read_b64_tr_b16 a[52:53], v16 offset:28672
    v_mfma_f32_16x16x32_bf16 v[156:159], v[2:5], a[80:83], v[156:159]
    ds_read_b64_tr_b16 a[54:55], v16 offset:29184
    v_mfma_f32_16x16x32_bf16 v[160:163], a[80:83], a[80:83], v[160:163]
    ds_read_b128 a[72:75], v13 offset:51200
    v_mfma_f32_16x16x32_bf16 v[116:119], a[0:3], a[28:31], v[116:119]
    ds_read_b128 a[76:79], v14 offset:51200
    v_mfma_f32_16x16x32_bf16 v[120:123], a[4:7], a[28:31], v[120:123]
    v_add_u32 v15, 61440, v15
    v_mfma_f32_16x16x32_bf16 v[124:127], a[8:11], a[28:31], v[124:127]
    ds_read_b128 a[84:87], v15 offset:0
    v_mfma_f32_16x16x32_bf16 v[128:131], a[12:15], a[28:31], v[128:131]
    v_mfma_f32_16x16x32_bf16 v[132:135], a[16:19], a[28:31], v[132:135]
    v_mfma_f32_16x16x32_bf16 v[144:147], v[2:5], a[28:31], v[144:147]
    v_mfma_f32_16x16x32_bf16 v[80:83], a[20:23], a[4:7], v[80:83]
    v_mfma_f32_16x16x32_bf16 v[84:87], a[20:23], a[8:11], v[84:87]
    v_mfma_f32_16x16x32_bf16 v[88:91], a[20:23], a[12:15], v[88:91]
    v_mfma_f32_16x16x32_bf16 v[92:95], a[20:23], a[16:19], v[92:95]
    v_mfma_f32_16x16x32_bf16 v[136:139], v[2:5], a[20:23], v[136:139]
    s_waitcnt lgkmcnt(0)
    s_waitcnt vmcnt(7)
    s_barrier
    v_mfma_f32_16x16x32_bf16 v[96:99], a[56:59], a[32:35], v[96:99]
    v_add_u32 v13, 61440, v13
    s_add_u32 m0, s66, 24576
    v_mfma_f32_16x16x32_bf16 v[100:103], a[56:59], a[36:39], v[100:103]
    buffer_load_dwordx4 v6, s[32:35], s79 offen lds
    v_add_u32 v14, 61440, v14
    v_mfma_f32_16x16x32_bf16 v[104:107], a[56:59], a[40:43], v[104:107]
    ds_read_b64_tr_b16 a[24:25], v17 offset:8192
    v_mfma_f32_16x16x32_bf16 v[108:111], a[56:59], a[44:47], v[108:111]
    ds_read_b64_tr_b16 a[26:27], v17 offset:8704
    s_add_u32 m0, s66, 25600
    v_mfma_f32_16x16x32_bf16 v[112:115], a[56:59], a[48:51], v[112:115]
    buffer_load_dwordx4 v7, s[32:35], s79 offen lds
    ds_read_b128 a[0:3], v11 offset:51200
    v_mfma_f32_16x16x32_bf16 v[140:143], v[2:5], a[56:59], v[140:143]
    ds_read_b128 a[4:7], v11 offset:53248
    v_mfma_f32_16x16x32_bf16 v[148:151], v[2:5], a[72:75], v[148:151]
    ds_read_b128 a[8:11], v11 offset:55296
    v_mfma_f32_16x16x32_bf16 v[152:155], a[72:75], a[72:75], v[152:155]
    ds_read_b128 a[12:15], v11 offset:57344
    s_add_u32 m0, s66, 31744
    v_mfma_f32_16x16x32_bf16 v[148:151], v[2:5], a[76:79], v[148:151]
    buffer_load_dwordx4 v6, s[32:35], s79 offen offset:1024 lds
    ds_read_b128 a[16:19], v11 offset:59392
    v_mfma_f32_16x16x32_bf16 v[152:155], a[76:79], a[76:79], v[152:155]
    ds_read_b64_tr_b16 a[28:29], v17 offset:16384
    v_mfma_f32_16x16x32_bf16 v[156:159], v[2:5], a[84:87], v[156:159]
    ds_read_b64_tr_b16 a[30:31], v17 offset:16896
    s_add_u32 m0, s66, 32768
    v_mfma_f32_16x16x32_bf16 v[160:163], a[84:87], a[84:87], v[160:163]
    buffer_load_dwordx4 v7, s[32:35], s79 offen offset:1024 lds
    ds_read_b64_tr_b16 a[20:21], v17 offset:0
    v_mfma_f32_16x16x32_bf16 v[116:119], a[32:35], a[60:63], v[116:119]
    ds_read_b64_tr_b16 a[22:23], v17 offset:512
    v_mfma_f32_16x16x32_bf16 v[120:123], a[36:39], a[60:63], v[120:123]
    ds_read_b128 a[64:67], v13 offset:0
    v_mfma_f32_16x16x32_bf16 v[124:127], a[40:43], a[60:63], v[124:127]
    ds_read_b128 a[68:71], v14 offset:0
    s_add_u32 m0, s66, 38912
    v_mfma_f32_16x16x32_bf16 v[128:131], a[44:47], a[60:63], v[128:131]
    buffer_load_dwordx4 v6, s[32:35], s79 offen offset:2048 lds
    v_mfma_f32_16x16x32_bf16 v[132:135], a[48:51], a[60:63], v[132:135]
    v_mfma_f32_16x16x32_bf16 v[144:147], v[2:5], a[60:63], v[144:147]
    s_add_u32 m0, s66, 39936
    v_mfma_f32_16x16x32_bf16 v[80:83], a[52:55], a[36:39], v[80:83]
    buffer_load_dwordx4 v7, s[32:35], s79 offen offset:2048 lds
    v_mfma_f32_16x16x32_bf16 v[84:87], a[52:55], a[40:43], v[84:87]
    v_mfma_f32_16x16x32_bf16 v[88:91], a[52:55], a[44:47], v[88:91]
    v_mfma_f32_16x16x32_bf16 v[92:95], a[52:55], a[48:51], v[92:95]
    buffer_load_dwordx4 v[252:255], v48, s[40:43], 0 offen
    v_mfma_f32_16x16x32_bf16 v[136:139], v[2:5], a[52:55], v[136:139]
    s_waitcnt lgkmcnt(0)
    v_mfma_f32_16x16x32_bf16 v[96:99], a[24:27], a[0:3], v[96:99]
    ds_read_b64_tr_b16 a[56:57], v17 offset:12288
    buffer_load_dwordx2 v[32:33], v31, s[48:51], 0 offen offset:896 sc1
    v_mfma_f32_16x16x32_bf16 v[100:103], a[24:27], a[4:7], v[100:103]
    ds_read_b64_tr_b16 a[58:59], v17 offset:12800
    buffer_load_dword v252, v34, s[48:51], 0 offen
    v_mfma_f32_16x16x32_bf16 v[104:107], a[24:27], a[8:11], v[104:107]
    ds_read_b128 a[32:35], v12 offset:51200
    global_load_ushort v36, v50, s[14:15] offset:0
    v_mfma_f32_16x16x32_bf16 v[108:111], a[24:27], a[12:15], v[108:111]
    ds_read_b128 a[36:39], v12 offset:53248
    global_load_ushort v37, v50, s[14:15] offset:64
    v_mfma_f32_16x16x32_bf16 v[112:115], a[24:27], a[16:19], v[112:115]
    ds_read_b128 a[40:43], v12 offset:55296
    global_load_ushort v38, v51, s[14:15] offset:0
    v_mfma_f32_16x16x32_bf16 v[140:143], v[2:5], a[24:27], v[140:143]
    ds_read_b128 a[44:47], v12 offset:57344
    global_load_ushort v39, v51, s[14:15] offset:64
    v_mfma_f32_16x16x32_bf16 v[148:151], v[2:5], a[64:67], v[148:151]
    ds_read_b128 a[48:51], v12 offset:59392
    global_load_dwordx2 v[40:41], v52, s[18:19] offset:0
    v_mfma_f32_16x16x32_bf16 v[152:155], a[64:67], a[64:67], v[152:155]
    ds_read_b64_tr_b16 a[60:61], v17 offset:20480
    global_load_dwordx2 v[42:43], v52, s[18:19] offset:16
    v_mfma_f32_16x16x32_bf16 v[148:151], v[2:5], a[68:71], v[148:151]
    ds_read_b64_tr_b16 a[62:63], v17 offset:20992
    global_load_dwordx2 v[44:45], v52, s[18:19] offset:32
    v_mfma_f32_16x16x32_bf16 v[152:155], a[68:71], a[68:71], v[152:155]
    ds_read_b64_tr_b16 a[52:53], v17 offset:4096
    global_load_dwordx2 v[46:47], v52, s[18:19] offset:48
    v_mfma_f32_16x16x32_bf16 v[116:119], a[0:3], a[28:31], v[116:119]
    ds_read_b64_tr_b16 a[54:55], v17 offset:4608
    v_mfma_f32_16x16x32_bf16 v[120:123], a[4:7], a[28:31], v[120:123]
    ds_read_b128 a[72:75], v13 offset:10240
    v_mfma_f32_16x16x32_bf16 v[124:127], a[8:11], a[28:31], v[124:127]
    ds_read_b128 a[76:79], v14 offset:10240
    v_mfma_f32_16x16x32_bf16 v[128:131], a[12:15], a[28:31], v[128:131]
    v_mfma_f32_16x16x32_bf16 v[132:135], a[16:19], a[28:31], v[132:135]
    v_mfma_f32_16x16x32_bf16 v[144:147], v[2:5], a[28:31], v[144:147]
    v_mfma_f32_16x16x32_bf16 v[80:83], a[20:23], a[4:7], v[80:83]
    v_mfma_f32_16x16x32_bf16 v[84:87], a[20:23], a[8:11], v[84:87]
    v_mfma_f32_16x16x32_bf16 v[88:91], a[20:23], a[12:15], v[88:91]
    v_mfma_f32_16x16x32_bf16 v[92:95], a[20:23], a[16:19], v[92:95]
    buffer_load_dwordx4 v[252:255], v49, s[40:43], 0 offen
    v_mfma_f32_16x16x32_bf16 v[136:139], v[2:5], a[20:23], v[136:139]
    s_waitcnt lgkmcnt(0)
    s_waitcnt vmcnt(18)
    s_barrier
    v_mfma_f32_16x16x32_bf16 v[96:99], a[56:59], a[32:35], v[96:99]
    v_add_u32 v11, 61440, v11
    s_add_u32 m0, s24, 0
    s_add_u32 s8, s13, 0
    v_mfma_f32_16x16x32_bf16 v[100:103], a[56:59], a[36:39], v[100:103]
    buffer_load_dwordx4 v22, s[36:39], s8 offen lds
    v_add_u32 v12, 61440, v12
    v_mfma_f32_16x16x32_bf16 v[104:107], a[56:59], a[40:43], v[104:107]
    ds_read_b64_tr_b16 a[24:25], v16 offset:8192
    s_mov_b32 s72, 0x22222222
    v_mfma_f32_16x16x32_bf16 v[108:111], a[56:59], a[44:47], v[108:111]
    ds_read_b64_tr_b16 a[26:27], v16 offset:8704
    s_mov_b32 s73, 0x22222222
    v_mfma_f32_16x16x32_bf16 v[112:115], a[56:59], a[48:51], v[112:115]
    buffer_load_dwordx4 v23, s[36:39], s8 offen offset:1024 lds
    ds_read_b128 a[0:3], v11 offset:0
    v_mfma_f32_16x16x32_bf16 v[140:143], v[2:5], a[56:59], v[140:143]
    ds_read_b128 a[4:7], v11 offset:2048
    s_mov_b32 s74, 0x44444444
    v_mfma_f32_16x16x32_bf16 v[148:151], v[2:5], a[72:75], v[148:151]
    ds_read_b128 a[8:11], v11 offset:4096
    s_mov_b32 s75, 0x44444444
    v_mfma_f32_16x16x32_bf16 v[152:155], a[72:75], a[72:75], v[152:155]
    buffer_load_dwordx4 v24, s[36:39], s8 offen offset:2048 lds
    ds_read_b128 a[12:15], v11 offset:6144
    v_mfma_f32_16x16x32_bf16 v[148:151], v[2:5], a[76:79], v[148:151]
    ds_read_b128 a[16:19], v11 offset:8192
    s_mov_b32 s76, 0x88888888
    v_mfma_f32_16x16x32_bf16 v[152:155], a[76:79], a[76:79], v[152:155]
    ds_read_b64_tr_b16 a[28:29], v16 offset:16384
    s_mov_b32 s77, 0x88888888
    v_mfma_f32_16x16x32_bf16 v[116:119], a[32:35], a[60:63], v[116:119]
    buffer_load_dwordx4 v25, s[36:39], s8 offen offset:3072 lds
    ds_read_b64_tr_b16 a[30:31], v16 offset:16896
    v_mfma_f32_16x16x32_bf16 v[120:123], a[36:39], a[60:63], v[120:123]
    ds_read_b64_tr_b16 a[20:21], v16 offset:0
    v_mfma_f32_16x16x32_bf16 v[124:127], a[40:43], a[60:63], v[124:127]
    ds_read_b64_tr_b16 a[22:23], v16 offset:512
    s_add_u32 m0, s24, 4096
    s_add_u32 s8, s13, 32768
    v_mfma_f32_16x16x32_bf16 v[128:131], a[44:47], a[60:63], v[128:131]
    buffer_load_dwordx4 v22, s[36:39], s8 offen lds
    v_mfma_f32_16x16x32_bf16 v[132:135], a[48:51], a[60:63], v[132:135]
    v_mfma_f32_16x16x32_bf16 v[144:147], v[2:5], a[60:63], v[144:147]
    v_mfma_f32_16x16x32_bf16 v[80:83], a[52:55], a[36:39], v[80:83]
    buffer_load_dwordx4 v23, s[36:39], s8 offen offset:1024 lds
    v_mfma_f32_16x16x32_bf16 v[84:87], a[52:55], a[40:43], v[84:87]
    v_mfma_f32_16x16x32_bf16 v[88:91], a[52:55], a[44:47], v[88:91]
    v_mfma_f32_16x16x32_bf16 v[92:95], a[52:55], a[48:51], v[92:95]
    buffer_load_dwordx4 v[252:255], v48, s[44:47], 0 offen
    v_mfma_f32_16x16x32_bf16 v[136:139], v[2:5], a[52:55], v[136:139]
    s_waitcnt lgkmcnt(0)
    v_mfma_f32_16x16x32_bf16 v[96:99], a[24:27], a[0:3], v[96:99]
    ds_read_b64_tr_b16 a[56:57], v16 offset:12288
    v_mfma_f32_16x16x32_bf16 v[100:103], a[24:27], a[4:7], v[100:103]
    ds_read_b64_tr_b16 a[58:59], v16 offset:12800
    v_mfma_f32_16x16x32_bf16 v[104:107], a[24:27], a[8:11], v[104:107]
    ds_read_b128 a[32:35], v12 offset:0
    v_cndmask_b32 v173, v160, v161, s[72:73]
    v_mfma_f32_16x16x32_bf16 v[108:111], a[24:27], a[12:15], v[108:111]
    ds_read_b128 a[36:39], v12 offset:2048
    v_mov_b32 v172, v156
    v_mfma_f32_16x16x32_bf16 v[112:115], a[24:27], a[16:19], v[112:115]
    ds_read_b128 a[40:43], v12 offset:4096
    v_cndmask_b32 v173, v173, v162, s[74:75]
    v_mfma_f32_16x16x32_bf16 v[140:143], v[2:5], a[24:27], v[140:143]
    ds_read_b128 a[44:47], v12 offset:6144
    v_cndmask_b32 v173, v173, v163, s[76:77]
    v_mfma_f32_16x16x32_bf16 v[116:119], a[0:3], a[28:31], v[116:119]
    ds_read_b128 a[48:51], v12 offset:8192
    v_cndmask_b32 v27, v152, v153, s[72:73]
    v_mfma_f32_16x16x32_bf16 v[120:123], a[4:7], a[28:31], v[120:123]
    ds_read_b64_tr_b16 a[60:61], v16 offset:20480
    v_mov_b32 v26, v148
    v_mfma_f32_16x16x32_bf16 v[124:127], a[8:11], a[28:31], v[124:127]
    ds_read_b64_tr_b16 a[62:63], v16 offset:20992
    v_cndmask_b32 v27, v27, v154, s[74:75]
    v_mfma_f32_16x16x32_bf16 v[128:131], a[12:15], a[28:31], v[128:131]
    ds_read_b64_tr_b16 a[52:53], v16 offset:4096
    v_cndmask_b32 v27, v27, v155, s[76:77]
    v_mfma_f32_16x16x32_bf16 v[132:135], a[16:19], a[28:31], v[132:135]
    ds_read_b64_tr_b16 a[54:55], v16 offset:4608
    ds_write_b64 v58, v[172:173]
    v_mfma_f32_16x16x32_bf16 v[144:147], v[2:5], a[28:31], v[144:147]
    ds_write_b64 v57, v[26:27]
    v_mfma_f32_16x16x32_bf16 v[80:83], a[20:23], a[4:7], v[80:83]
    v_mfma_f32_16x16x32_bf16 v[84:87], a[20:23], a[8:11], v[84:87]
    v_mfma_f32_16x16x32_bf16 v[88:91], a[20:23], a[12:15], v[88:91]
    v_mfma_f32_16x16x32_bf16 v[92:95], a[20:23], a[16:19], v[92:95]
    buffer_load_dwordx4 v[252:255], v49, s[44:47], 0 offen
    v_mfma_f32_16x16x32_bf16 v[136:139], v[2:5], a[20:23], v[136:139]
    s_waitcnt lgkmcnt(0)
    s_waitcnt vmcnt(20)
    s_barrier
    v_mfma_f32_16x16x32_bf16 v[96:99], a[56:59], a[32:35], v[96:99]
    ds_read_b64_tr_b16 a[24:25], v16 offset:32768
    s_add_u32 m0, s24, -49152
    s_add_u32 s8, s13, 98304
    v_mfma_f32_16x16x32_bf16 v[100:103], a[56:59], a[36:39], v[100:103]
    buffer_load_dwordx4 v22, s[36:39], s8 offen lds
    ds_read_b64_tr_b16 a[26:27], v16 offset:33280
    v_mfma_f32_16x16x32_bf16 v[104:107], a[56:59], a[40:43], v[104:107]
    ds_read_b128 a[0:3], v11 offset:10240
    ds_read_b64 v[182:183], v59 offset:1024
    v_mfma_f32_16x16x32_bf16 v[108:111], a[56:59], a[44:47], v[108:111]
    buffer_load_dwordx4 v23, s[36:39], s8 offen offset:1024 lds
    ds_read_b128 a[4:7], v11 offset:12288
    v_mfma_f32_16x16x32_bf16 v[112:115], a[56:59], a[48:51], v[112:115]
    ds_read_b128 a[8:11], v11 offset:14336
    ds_read_b64 v[184:185], v59 offset:1152
    v_mfma_f32_16x16x32_bf16 v[140:143], v[2:5], a[56:59], v[140:143]
    ds_read_b128 a[12:15], v11 offset:16384
    ds_read_b64 v[186:187], v59 offset:1280
    v_mfma_f32_16x16x32_bf16 v[116:119], a[32:35], a[60:63], v[116:119]
    buffer_load_dwordx4 v24, s[36:39], s8 offen offset:2048 lds
    ds_read_b128 a[16:19], v11 offset:18432
    v_mfma_f32_16x16x32_bf16 v[120:123], a[36:39], a[60:63], v[120:123]
    ds_read_b64_tr_b16 a[28:29], v16 offset:40960
    ds_read_b64 v[188:189], v59 offset:1408
    v_mfma_f32_16x16x32_bf16 v[124:127], a[40:43], a[60:63], v[124:127]
    buffer_load_dwordx4 v25, s[36:39], s8 offen offset:3072 lds
    ds_read_b64_tr_b16 a[30:31], v16 offset:41472
    v_mfma_f32_16x16x32_bf16 v[128:131], a[44:47], a[60:63], v[128:131]
    ds_read_b64_tr_b16 a[20:21], v16 offset:24576
    ds_read_b64 v[174:175], v59 offset:128
    v_mfma_f32_16x16x32_bf16 v[132:135], a[48:51], a[60:63], v[132:135]
    ds_read_b64_tr_b16 a[22:23], v16 offset:25088
    s_add_u32 m0, s24, -45056
    s_add_u32 s8, s13, 131072
    v_mfma_f32_16x16x32_bf16 v[144:147], v[2:5], a[60:63], v[144:147]
    buffer_load_dwordx4 v22, s[36:39], s8 offen lds
    ds_read_b64 v[176:177], v59 offset:256
    v_mfma_f32_16x16x32_bf16 v[80:83], a[52:55], a[36:39], v[80:83]
    ds_read_b64 v[178:179], v59 offset:384
    ds_read_b64 v[180:181], v59 offset:512
    v_mfma_f32_16x16x32_bf16 v[84:87], a[52:55], a[40:43], v[84:87]
    buffer_load_dwordx4 v23, s[36:39], s8 offen offset:1024 lds
    s_waitcnt lgkmcnt(12)
    v_add_f32 v182, v182, v184
    v_mfma_f32_16x16x32_bf16 v[88:91], a[52:55], a[44:47], v[88:91]
    v_add_f32 v183, v183, v185
    s_waitcnt lgkmcnt(7)
    v_add_f32 v186, v186, v188
    v_mfma_f32_16x16x32_bf16 v[92:95], a[52:55], a[48:51], v[92:95]
    v_add_f32 v187, v187, v189
    v_add_f32 v182, v182, v186
    v_mfma_f32_16x16x32_bf16 v[136:139], v[2:5], a[52:55], v[136:139]
    v_add_f32 v183, v183, v187
    s_waitcnt lgkmcnt(0)
    v_mfma_f32_16x16x32_bf16 v[96:99], a[24:27], a[0:3], v[96:99]
    ds_read_b64_tr_b16 a[56:57], v16 offset:36864
    ds_read_b64 v[164:165], v64 offset:0
    v_mfma_f32_16x16x32_bf16 v[100:103], a[24:27], a[4:7], v[100:103]
    ds_read_b64_tr_b16 a[58:59], v16 offset:37376
    ds_read_b64 v[166:167], v65 offset:0
    v_mfma_f32_16x16x32_bf16 v[104:107], a[24:27], a[8:11], v[104:107]
    ds_read_b128 a[32:35], v12 offset:10240
    ds_read_b64 v[168:169], v66 offset:0
    v_mfma_f32_16x16x32_bf16 v[108:111], a[24:27], a[12:15], v[108:111]
    ds_read_b128 a[36:39], v12 offset:12288
    ds_read_b64 v[170:171], v67 offset:0
    v_mfma_f32_16x16x32_bf16 v[112:115], a[24:27], a[16:19], v[112:115]
    ds_read_b128 a[40:43], v12 offset:14336
    v_mul_f32 v28, 0xba000000, v174
    v_mfma_f32_16x16x32_bf16 v[140:143], v[2:5], a[24:27], v[140:143]
    ds_read_b128 a[44:47], v12 offset:16384
    v_mul_f32 v231, 0xba000000, v176
    v_mfma_f32_16x16x32_bf16 v[116:119], a[0:3], a[28:31], v[116:119]
    ds_read_b128 a[48:51], v12 offset:18432
    v_mul_f32 v235, 0xba000000, v178
    v_mfma_f32_16x16x32_bf16 v[120:123], a[4:7], a[28:31], v[120:123]
    ds_read_b64_tr_b16 a[60:61], v16 offset:45056
    v_mul_f32 v239, 0xba000000, v180
    v_mfma_f32_16x16x32_bf16 v[124:127], a[8:11], a[28:31], v[124:127]
    ds_read_b64_tr_b16 a[62:63], v16 offset:45568
    v_mul_f32 v243, 0xba000000, v182
    v_mfma_f32_16x16x32_bf16 v[128:131], a[12:15], a[28:31], v[128:131]
    ds_read_b64_tr_b16 a[52:53], v16 offset:28672
    v_fmaak_f32 v228, v175, v56, 0x3727c5ac
    v_mfma_f32_16x16x32_bf16 v[132:135], a[16:19], a[28:31], v[132:135]
    ds_read_b64_tr_b16 a[54:55], v16 offset:29184
    v_fmaak_f32 v232, v177, v56, 0x3727c5ac
    v_mfma_f32_16x16x32_bf16 v[144:147], v[2:5], a[28:31], v[144:147]
    v_fmaak_f32 v236, v179, v56, 0x3727c5ac
    v_fmaak_f32 v240, v181, v56, 0x3727c5ac
    v_mfma_f32_16x16x32_bf16 v[80:83], a[20:23], a[4:7], v[80:83]
    v_fmaak_f32 v244, v183, v56, 0x3727c5ac
    v_mul_f32 v229, v56, v174
    v_mfma_f32_16x16x32_bf16 v[84:87], a[20:23], a[8:11], v[84:87]
    v_mul_f32 v233, v56, v176
    v_mul_f32 v237, v56, v178
    v_mfma_f32_16x16x32_bf16 v[88:91], a[20:23], a[12:15], v[88:91]
    v_mul_f32 v241, v56, v180
    v_mul_f32 v245, v56, v182
    v_mfma_f32_16x16x32_bf16 v[92:95], a[20:23], a[16:19], v[92:95]
    v_fma_f32 v228, -v229, v229, v228
    v_fma_f32 v232, -v233, v233, v232
    v_mfma_f32_16x16x32_bf16 v[136:139], v[2:5], a[20:23], v[136:139]
    v_fma_f32 v236, -v237, v237, v236
    v_fma_f32 v240, -v241, v241, v240
    v_fma_f32 v244, -v245, v245, v244
    v_rsq_f32 v212, v228
    v_rsq_f32 v214, v232
    v_rsq_f32 v216, v236
    v_rsq_f32 v218, v240
    v_rsq_f32 v210, v244
    s_waitcnt lgkmcnt(0)
    v_mfma_f32_16x16x32_bf16 v[96:99], a[56:59], a[32:35], v[96:99]
    v_cvt_pk_bf16_f32 v229, v28, v28
    v_cvt_pk_bf16_f32 v233, v231, v231
    v_mfma_f32_16x16x32_bf16 v[100:103], a[56:59], a[36:39], v[100:103]
    v_cvt_pk_bf16_f32 v237, v235, v235
    v_cvt_pk_bf16_f32 v241, v239, v239
    v_mfma_f32_16x16x32_bf16 v[104:107], a[56:59], a[40:43], v[104:107]
    v_cvt_pk_bf16_f32 v245, v243, v243
    v_and_b32 v229, 0xffff0000, v229
    v_mfma_f32_16x16x32_bf16 v[108:111], a[56:59], a[44:47], v[108:111]
    v_and_b32 v233, 0xffff0000, v233
    v_and_b32 v237, 0xffff0000, v237
    v_mfma_f32_16x16x32_bf16 v[112:115], a[56:59], a[48:51], v[112:115]
    v_and_b32 v241, 0xffff0000, v241
    v_and_b32 v245, 0xffff0000, v245
    v_mfma_f32_16x16x32_bf16 v[140:143], v[2:5], a[56:59], v[140:143]
    v_sub_f32 v230, v28, v229
    v_sub_f32 v234, v231, v233
    v_mfma_f32_16x16x32_bf16 v[116:119], a[32:35], a[60:63], v[116:119]
    v_sub_f32 v238, v235, v237
    v_sub_f32 v242, v239, v241
    v_mfma_f32_16x16x32_bf16 v[120:123], a[36:39], a[60:63], v[120:123]
    v_sub_f32 v246, v243, v245
    v_cvt_pk_bf16_f32 v192, v229, v230
    v_mfma_f32_16x16x32_bf16 v[124:127], a[40:43], a[60:63], v[124:127]
    v_cvt_pk_bf16_f32 v194, v233, v234
    v_cvt_pk_bf16_f32 v196, v237, v238
    v_mfma_f32_16x16x32_bf16 v[128:131], a[44:47], a[60:63], v[128:131]
    v_cvt_pk_bf16_f32 v198, v241, v242
    v_cvt_pk_bf16_f32 v190, v245, v246
    v_mfma_f32_16x16x32_bf16 v[132:135], a[48:51], a[60:63], v[132:135]
    v_mov_b32 v193, v192
    v_mov_b32 v195, v194
    v_mfma_f32_16x16x32_bf16 v[144:147], v[2:5], a[60:63], v[144:147]
    v_mov_b32 v197, v196
    v_mov_b32 v199, v198
    v_mfma_f32_16x16x32_bf16 v[80:83], a[52:55], a[36:39], v[80:83]
    v_mov_b32 v191, v190
    v_cvt_pk_bf16_f32 v229, v212, v212
    v_mfma_f32_16x16x32_bf16 v[84:87], a[52:55], a[40:43], v[84:87]
    v_cvt_pk_bf16_f32 v233, v214, v214
    v_cvt_pk_bf16_f32 v237, v216, v216
    v_mfma_f32_16x16x32_bf16 v[88:91], a[52:55], a[44:47], v[88:91]
    v_cvt_pk_bf16_f32 v241, v218, v218
    v_cvt_pk_bf16_f32 v245, v210, v210
    v_mfma_f32_16x16x32_bf16 v[92:95], a[52:55], a[48:51], v[92:95]
    v_and_b32 v229, 0xffff0000, v229
    v_and_b32 v233, 0xffff0000, v233
    v_mfma_f32_16x16x32_bf16 v[136:139], v[2:5], a[52:55], v[136:139]
    v_and_b32 v237, 0xffff0000, v237
    v_and_b32 v241, 0xffff0000, v241
    v_and_b32 v245, 0xffff0000, v245
    v_sub_f32 v230, v212, v229
    v_sub_f32 v234, v214, v233
    v_sub_f32 v238, v216, v237
    v_sub_f32 v242, v218, v241
    v_sub_f32 v246, v210, v245
    v_cvt_pk_bf16_f32 v202, v229, v230
    v_cvt_pk_bf16_f32 v204, v233, v234
    v_cvt_pk_bf16_f32 v206, v237, v238
    v_cvt_pk_bf16_f32 v208, v241, v242
    v_cvt_pk_bf16_f32 v200, v245, v246
    v_mov_b32 v203, v202
    v_mov_b32 v205, v204
    v_mov_b32 v207, v206
    v_mov_b32 v209, v208
    v_mov_b32 v201, v200
    v_mul_f32 v220, 0x3eb8aa3b, v212
    v_mul_f32 v222, 0x3eb8aa3b, v214
    v_mul_f32 v224, 0x3eb8aa3b, v216
    v_mul_f32 v226, 0x3eb8aa3b, v218
    s_barrier
    s_mov_b32 m0, s25
    s_mov_b32 s8, s17
    v_mfma_f32_16x16x16_bf16 v[6:9], v[200:201], v[62:63], 0
    buffer_load_dwordx4 v22, s[36:39], s8 offen lds
    v_mfma_f32_16x16x16_bf16 v[10:13], v[202:203], v[62:63], 0
    v_mfma_f32_16x16x16_bf16 v[14:17], v[204:205], v[62:63], 0
    v_mfma_f32_16x16x16_bf16 v[48:51], v[206:207], v[62:63], 0
    v_mfma_f32_16x16x16_bf16 v[56:59], v[208:209], v[62:63], 0
    buffer_load_dwordx4 v23, s[36:39], s8 offen offset:1024 lds
    v_cvt_pk_bf16_f32 v34, v140, v140
    v_cvt_pk_bf16_f32 v26, v136, v136
    v_cvt_pk_bf16_f32 v64, v144, v144
    v_and_b32 v148, 0xffff0000, v34
    v_and_b32 v66, 0xffff0000, v26
    buffer_load_dwordx4 v24, s[36:39], s8 offen offset:2048 lds
    v_and_b32 v150, 0xffff0000, v64
    v_sub_f32 v149, v140, v148
    v_sub_f32 v67, v136, v66
    v_sub_f32 v151, v144, v150
    v_cvt_pk_bf16_f32 v35, v149, v149
    buffer_load_dwordx4 v25, s[36:39], s8 offen offset:3072 lds
    v_cvt_pk_bf16_f32 v27, v67, v67
    v_cvt_pk_bf16_f32 v65, v151, v151
    v_mfma_f32_16x16x16_bf16 v[96:99], v[34:35], v[190:191], v[96:99]
    v_mfma_f32_16x16x16_bf16 v[100:103], v[34:35], v[192:193], v[100:103]
    s_add_u32 m0, s21, 0
    s_add_u32 s9, s26, 0
    v_mfma_f32_16x16x16_bf16 v[104:107], v[34:35], v[194:195], v[104:107]
    buffer_load_dwordx4 v18, s[40:43], s9 offen lds
    v_mfma_f32_16x16x16_bf16 v[108:111], v[34:35], v[196:197], v[108:111]
    v_mfma_f32_16x16x16_bf16 v[112:115], v[34:35], v[198:199], v[112:115]
    v_mfma_f32_16x16x16_bf16 v[80:83], v[26:27], v[192:193], v[80:83]
    v_mfma_f32_16x16x16_bf16 v[84:87], v[26:27], v[194:195], v[84:87]
    v_mfma_f32_16x16x16_bf16 v[88:91], v[26:27], v[196:197], v[88:91]
    buffer_load_dwordx4 v19, s[40:43], s9 offen offset:1024 lds
    v_mfma_f32_16x16x16_bf16 v[92:95], v[26:27], v[198:199], v[92:95]
    v_mfma_f32_16x16x16_bf16 v[116:119], v[190:191], v[64:65], v[116:119]
    v_mfma_f32_16x16x16_bf16 v[120:123], v[192:193], v[64:65], v[120:123]
    v_mfma_f32_16x16x16_bf16 v[124:127], v[194:195], v[64:65], v[124:127]
    v_mfma_f32_16x16x16_bf16 v[128:131], v[196:197], v[64:65], v[128:131]
    buffer_load_dwordx4 v20, s[40:43], s9 offen offset:2048 lds
    v_mfma_f32_16x16x16_bf16 v[132:135], v[198:199], v[64:65], v[132:135]
    v_pk_mul_f32 v[96:97], v[96:97], v[210:211] op_sel_hi:[1,0]
    v_pk_mul_f32 v[100:101], v[100:101], v[212:213] op_sel_hi:[1,0]
    v_pk_mul_f32 v[104:105], v[104:105], v[214:215] op_sel_hi:[1,0]
    v_pk_mul_f32 v[108:109], v[108:109], v[216:217] op_sel_hi:[1,0]
    buffer_load_dwordx4 v21, s[40:43], s9 offen offset:3072 lds
    v_pk_mul_f32 v[112:113], v[112:113], v[218:219] op_sel_hi:[1,0]
    v_pk_mul_f32 v[98:99], v[98:99], v[210:211] op_sel_hi:[1,0]
    v_pk_mul_f32 v[102:103], v[102:103], v[212:213] op_sel_hi:[1,0]
    v_pk_mul_f32 v[106:107], v[106:107], v[214:215] op_sel_hi:[1,0]
    s_add_u32 m0, s21, 4096
    s_add_u32 s9, s26, 114688
    v_pk_mul_f32 v[110:111], v[110:111], v[216:217] op_sel_hi:[1,0]
    buffer_load_dwordx4 v18, s[40:43], s9 offen lds
    v_pk_mul_f32 v[114:115], v[114:115], v[218:219] op_sel_hi:[1,0]
    v_cvt_pk_bf16_f32 v66, v96, v97
    v_cvt_pk_bf16_f32 v136, v100, v101
    v_cvt_pk_bf16_f32 v138, v104, v105
    v_cvt_pk_bf16_f32 v140, v108, v109
    buffer_load_dwordx4 v19, s[40:43], s9 offen offset:1024 lds
    v_cvt_pk_bf16_f32 v142, v112, v113
    v_cvt_pk_bf16_f32 v67, v98, v99
    v_cvt_pk_bf16_f32 v137, v102, v103
    v_cvt_pk_bf16_f32 v139, v106, v107
    v_cvt_pk_bf16_f32 v141, v110, v111
    buffer_load_dwordx4 v20, s[40:43], s9 offen offset:2048 lds
    v_cvt_pk_bf16_f32 v143, v114, v115
    v_cvt_pk_bf16_f32 v26, v80, v81
    v_cvt_pk_bf16_f32 v34, v84, v85
    v_cvt_pk_bf16_f32 v62, v88, v89
    v_cvt_pk_bf16_f32 v64, v92, v93
    buffer_load_dwordx4 v21, s[40:43], s9 offen offset:3072 lds
    v_cvt_pk_bf16_f32 v27, v82, v83
    v_cvt_pk_bf16_f32 v35, v86, v87
    v_cvt_pk_bf16_f32 v63, v90, v91
    v_cvt_pk_bf16_f32 v65, v94, v95
    v_mfma_f32_16x16x16_bf16 v[80:83], v[66:67], v[26:27], v[76:79]
    v_mul_f32 v116, v6, v116
    v_mul_f32 v117, v7, v117
    v_mul_f32 v118, v8, v118
    v_mul_f32 v119, v9, v119
    v_mfma_f32_16x16x16_bf16 v[84:87], v[136:137], v[26:27], v[72:75]
    v_cvt_pk_bf16_f32 v144, v116, v117
    v_cvt_pk_bf16_f32 v145, v118, v119
    v_mul_f32 v120, v10, v120
    v_mul_f32 v121, v11, v121
    v_mfma_f32_16x16x16_bf16 v[108:111], v[136:137], v[34:35], v[68:71]
    v_mul_f32 v122, v12, v122
    v_mul_f32 v123, v13, v123
    v_cvt_pk_bf16_f32 v146, v120, v121
    v_cvt_pk_bf16_f32 v147, v122, v123
    v_mfma_f32_16x16x16_bf16 v[112:115], v[138:139], v[34:35], v[72:75]
    v_mul_f32 v124, v14, v124
    v_mul_f32 v125, v15, v125
    v_mul_f32 v126, v16, v126
    v_mul_f32 v127, v17, v127
    v_mfma_f32_16x16x16_bf16 v[182:185], v[138:139], v[62:63], v[68:71]
    v_cvt_pk_bf16_f32 v148, v124, v125
    v_cvt_pk_bf16_f32 v149, v126, v127
    v_mul_f32 v128, v48, v128
    v_mul_f32 v129, v49, v129
    v_mfma_f32_16x16x16_bf16 v[186:189], v[140:141], v[62:63], v[72:75]
    v_mul_f32 v130, v50, v130
    v_mul_f32 v131, v51, v131
    v_cvt_pk_bf16_f32 v150, v128, v129
    v_cvt_pk_bf16_f32 v151, v130, v131
    v_mfma_f32_16x16x16_bf16 v[210:213], v[140:141], v[64:65], v[68:71]
    v_mul_f32 v132, v56, v132
    v_mul_f32 v133, v57, v133
    v_mul_f32 v134, v58, v134
    v_mul_f32 v135, v59, v135
    v_mfma_f32_16x16x16_bf16 v[214:217], v[142:143], v[64:65], v[72:75]
    v_cvt_pk_bf16_f32 v152, v132, v133
    v_cvt_pk_bf16_f32 v153, v134, v135
    v_max_f32 v100, v80, v81
    v_max_f32 v176, v108, v109
    v_max_f32 v202, v182, v183
    v_max_f32 v240, v210, v211
    v_max_f32 v101, v82, v83
    v_max_f32 v177, v110, v111
    v_max_f32 v203, v184, v185
    v_max_f32 v241, v212, v213
    v_max_f32 v102, v84, v85
    v_max_f32 v178, v112, v113
    v_max_f32 v204, v186, v187
    v_max_f32 v242, v214, v215
    v_max_f32 v103, v86, v87
    v_max_f32 v179, v114, v115
    v_max_f32 v205, v188, v189
    v_max_f32 v243, v216, v217
    v_max3_f32 v104, v100, v101, v102
    v_max3_f32 v162, v176, v177, v178
    v_max3_f32 v206, v202, v203, v204
    v_max3_f32 v218, v240, v241, v242
    v_max_f32 v104, v104, v103
    v_max_f32 v162, v162, v179
    v_max_f32 v206, v206, v205
    v_max_f32 v218, v218, v243
    v_permlane32_swap_b32 v104, v162
    s_nop 0
    v_permlane32_swap_b32 v206, v218
    v_max_f32 v104, v104, v162
    v_max_f32 v206, v206, v218
    s_nop 1
    v_permlane16_swap_b32 v104, v206
    v_max_f32 v104, v104, v206
    v_mov_b32 v206, v104
    s_nop 1
    v_permlane16_swap_b32 v104, v206
    v_mov_b32 v162, v104
    v_mov_b32 v218, v206
    s_nop 0
    v_permlane32_swap_b32 v104, v162
    v_permlane32_swap_b32 v206, v218
    v_mul_f32 v104, v220, v104
    v_mul_f32 v162, v222, v162
    v_mul_f32 v206, v224, v206
    v_mul_f32 v218, v226, v218
    v_pk_fma_f32 v[100:101], v[100:101], v[220:221], v[104:105] op_sel_hi:[1,0,0] neg_lo:[0,0,1] neg_hi:[0,0,1]
    v_pk_fma_f32 v[176:177], v[176:177], v[222:223], v[162:163] op_sel_hi:[1,0,0] neg_lo:[0,0,1] neg_hi:[0,0,1]
    v_pk_fma_f32 v[202:203], v[202:203], v[224:225], v[206:207] op_sel_hi:[1,0,0] neg_lo:[0,0,1] neg_hi:[0,0,1]
    v_pk_fma_f32 v[240:241], v[240:241], v[226:227], v[218:219] op_sel_hi:[1,0,0] neg_lo:[0,0,1] neg_hi:[0,0,1]
    v_pk_fma_f32 v[102:103], v[102:103], v[220:221], v[104:105] op_sel_hi:[1,0,0] neg_lo:[0,0,1] neg_hi:[0,0,1]
    v_pk_fma_f32 v[178:179], v[178:179], v[222:223], v[162:163] op_sel_hi:[1,0,0] neg_lo:[0,0,1] neg_hi:[0,0,1]
    v_pk_fma_f32 v[204:205], v[204:205], v[224:225], v[206:207] op_sel_hi:[1,0,0] neg_lo:[0,0,1] neg_hi:[0,0,1]
    v_pk_fma_f32 v[242:243], v[242:243], v[226:227], v[218:219] op_sel_hi:[1,0,0] neg_lo:[0,0,1] neg_hi:[0,0,1]
    v_exp_f32 v100, v100
    v_exp_f32 v176, v176
    v_exp_f32 v202, v202
    v_exp_f32 v240, v240
    v_exp_f32 v101, v101
    v_exp_f32 v177, v177
    v_exp_f32 v203, v203
    v_exp_f32 v241, v241
    v_exp_f32 v102, v102
    v_exp_f32 v178, v178
    v_exp_f32 v204, v204
    v_exp_f32 v242, v242
    v_exp_f32 v103, v103
    v_exp_f32 v179, v179
    v_exp_f32 v205, v205
    v_exp_f32 v243, v243
    v_cvt_pk_bf16_f32 v106, v100, v101
    v_cvt_pk_bf16_f32 v180, v176, v177
    v_cvt_pk_bf16_f32 v208, v202, v203
    v_cvt_pk_bf16_f32 v244, v240, v241
    v_cvt_pk_bf16_f32 v107, v102, v103
    v_cvt_pk_bf16_f32 v181, v178, v179
    v_cvt_pk_bf16_f32 v209, v204, v205
    v_cvt_pk_bf16_f32 v245, v242, v243
    v_perm_b32 v88, v106, v106, v54
    v_perm_b32 v154, v180, v180, v54
    v_perm_b32 v190, v208, v208, v54
    v_perm_b32 v228, v244, v244, v54
    v_perm_b32 v89, v106, v106, v55
    v_perm_b32 v155, v180, v180, v55
    v_perm_b32 v191, v208, v208, v55
    v_perm_b32 v229, v244, v244, v55
    v_perm_b32 v90, v107, v107, v54
    v_perm_b32 v156, v181, v181, v54
    v_perm_b32 v192, v209, v209, v54
    v_perm_b32 v230, v245, v245, v54
    v_perm_b32 v91, v107, v107, v55
    v_perm_b32 v157, v181, v181, v55
    v_perm_b32 v193, v209, v209, v55
    v_perm_b32 v231, v245, v245, v55
    v_mfma_f32_16x16x32_bf16 v[96:99], v[2:5], v[88:91], 0
    v_mfma_f32_16x16x32_bf16 v[172:175], v[2:5], v[154:157], 0
    v_mfma_f32_16x16x32_bf16 v[198:201], v[2:5], v[190:193], 0
    v_mfma_f32_16x16x32_bf16 v[236:239], v[2:5], v[228:231], 0
    v_mfma_f32_16x16x32_bf16 v[92:95], v[144:147], v[88:91], 0
    v_mfma_f32_16x16x32_bf16 v[158:161], v[146:149], v[154:157], 0
    v_mfma_f32_16x16x32_bf16 v[194:197], v[148:151], v[190:193], 0
    v_mfma_f32_16x16x32_bf16 v[232:235], v[150:153], v[228:231], 0
    s_nop 0
    v_rcp_f32 v96, v96
    v_rcp_f32 v172, v172
    v_rcp_f32 v198, v198
    v_rcp_f32 v236, v236
    v_pk_mul_f32 v[92:93], v[92:93], v[96:97] op_sel_hi:[1,0]
    v_pk_mul_f32 v[158:159], v[158:159], v[172:173] op_sel_hi:[1,0]
    v_pk_mul_f32 v[194:195], v[194:195], v[198:199] op_sel_hi:[1,0]
    v_pk_mul_f32 v[232:233], v[232:233], v[236:237] op_sel_hi:[1,0]
    v_pk_mul_f32 v[94:95], v[94:95], v[96:97] op_sel_hi:[1,0]
    v_pk_mul_f32 v[160:161], v[160:161], v[172:173] op_sel_hi:[1,0]
    v_pk_mul_f32 v[196:197], v[196:197], v[198:199] op_sel_hi:[1,0]
    v_pk_mul_f32 v[234:235], v[234:235], v[236:237] op_sel_hi:[1,0]
    v_cvt_pk_bf16_f32 v92, v92, v93
    v_cvt_pk_bf16_f32 v158, v158, v159
    v_cvt_pk_bf16_f32 v194, v194, v195
    v_cvt_pk_bf16_f32 v232, v232, v233
    v_cvt_pk_bf16_f32 v93, v94, v95
    v_cvt_pk_bf16_f32 v159, v160, v161
    v_cvt_pk_bf16_f32 v195, v196, v197
    v_cvt_pk_bf16_f32 v233, v234, v235
    buffer_store_dwordx2 v[92:93], v60, s[48:51], 0 offen sc1
    buffer_store_dwordx2 v[158:159], v61, s[48:51], 0 offen sc1
    buffer_store_dwordx2 v[194:195], v60, s[48:51], s96 offen sc1
    buffer_store_dwordx2 v[232:233], v61, s[48:51], s96 offen sc1
    s_add_u32 m0, s21, 8192
    s_add_u32 s9, s26, 229376
    buffer_load_dwordx4 v18, s[40:43], s9 offen lds
    buffer_load_dwordx4 v19, s[40:43], s9 offen offset:1024 lds
    buffer_load_dwordx4 v20, s[40:43], s9 offen offset:2048 lds
    buffer_load_dwordx4 v21, s[40:43], s9 offen offset:3072 lds
    s_add_u32 m0, s21, 12288
    s_add_u32 s9, s26, 344064
    buffer_load_dwordx4 v18, s[40:43], s9 offen lds
    buffer_load_dwordx4 v19, s[40:43], s9 offen offset:1024 lds
    buffer_load_dwordx4 v20, s[40:43], s9 offen offset:2048 lds
    buffer_load_dwordx4 v21, s[40:43], s9 offen offset:3072 lds
    s_waitcnt vmcnt(48)
    v_readfirstlane_b32 s94, v32
    v_readfirstlane_b32 s95, v33
    s_add_u32 s94, s94, 2
    s_or_b32 s94, s94, 1
    v_mov_b32 v32, s94
    v_mov_b32 v33, s95
    v_bfe_u32 v13, v0, 2, 2
    v_lshrrev_b32 v14, 5, v0
    v_lshl_add_u32 v13, v14, 3, v13
    v_lshlrev_b32 v13, 7, v13
    v_bfe_u32 v14, v0, 3, 1
    v_lshl_add_u32 v13, v14, 6, v13
    v_bfe_u32 v14, v0, 4, 1
    v_lshl_add_u32 v13, v14, 5, v13
    v_and_b32 v14, 3, v0
    v_lshl_add_u32 v13, v14, 3, v13
    s_lshl_b32 s5, s69, 6
    v_xor_b32 v13, s5, v13
    s_mul_i32 s4, s69, 12288
    s_add_u32 s4, s4, 131072
    v_add_u32 v6, s4, v13
    v_xor_b32 v9, 64, v6
    s_mul_i32 s4, s69, 12288
    s_add_u32 s4, s4, 81920
    v_add_u32 v7, s4, v13
    v_xor_b32 v10, 64, v7
    s_mul_i32 s4, s69, 8192
    s_add_u32 s4, s4, 106496
    v_add_u32 v8, s4, v13
    v_xor_b32 v11, 64, v8
    s_lshl_b32 s4, s59, 17
    s_lshl_b32 s5, s70, 16
    s_add_u32 s4, s4, s5
    s_lshl_b32 s5, s69, 15
    s_add_u32 s4, s4, s5
    v_add_u32 v13, 40, v0
    v_bfe_u32 v13, v13, 6, 1
    v_lshlrev_b32 v13, 7, v13
    v_lshl_add_u32 v15, v0, 4, v13
    v_add_u32 v12, s4, v15
    v_lshlrev_b32 v13, 4, v0
    s_lshl_b32 s4, s56, 12
    s_add_u32 s4, s4, 131072
    v_add_u32 v16, s4, v13
    s_xor_b32 s4, s56, 2
    s_lshl_b32 s4, s4, 12
    s_add_u32 s4, s4, 131072
    v_add_u32 v17, s4, v13
    s_lshl_b32 s4, s59, 1
    s_add_u32 s4, s4, s70
    s_lshl_b32 s5, s4, 16
    s_lshl_b32 s6, s58, 13
    s_add_u32 s5, s5, s6
    s_lshl_b32 s6, s69, 12
    s_add_u32 s5, s5, s6
    s_add_u32 s5, s5, 4194304
    v_add_u32 v26, s5, v15
    s_lshl_b32 s5, s4, 13
    s_lshl_b32 s6, s58, 10
    s_add_u32 s5, s5, s6
    s_lshl_b32 s6, s69, 9
    s_add_u32 s5, s5, s6
    s_add_u32 s5, s5, 8388608
    v_lshlrev_b32 v14, 3, v0
    v_add_u32 v27, s5, v14
    s_waitcnt vmcnt(8)
    s_barrier
    s_cmp_eq_u32 s56, 0
    s_cselect_b64 exec, 1, 0
    buffer_store_dwordx2 v[32:33], v30, s[48:51], 0 offen offset:0
    s_mov_b64 exec, -1
    ds_read_b64_tr_b16 a[0:1], v6 offset:0
    ds_read_b64_tr_b16 a[2:3], v6 offset:512
    ds_read_b64_tr_b16 a[4:5], v9 offset:0
    ds_read_b64_tr_b16 a[6:7], v9 offset:512
    ds_read_b64_tr_b16 a[8:9], v6 offset:2048
    ds_read_b64_tr_b16 a[10:11], v6 offset:2560
    ds_read_b64_tr_b16 a[12:13], v9 offset:2048
    ds_read_b64_tr_b16 a[14:15], v9 offset:2560
    ds_read_b64_tr_b16 a[16:17], v6 offset:4096
    ds_read_b64_tr_b16 a[18:19], v6 offset:4608
    ds_read_b64_tr_b16 a[20:21], v9 offset:4096
    ds_read_b64_tr_b16 a[22:23], v9 offset:4608
    ds_read_b64_tr_b16 a[24:25], v6 offset:6144
    ds_read_b64_tr_b16 a[26:27], v6 offset:6656
    ds_read_b64_tr_b16 a[28:29], v9 offset:6144
    ds_read_b64_tr_b16 a[30:31], v9 offset:6656
    ds_read_b64_tr_b16 a[32:33], v6 offset:8192
    ds_read_b64_tr_b16 a[34:35], v6 offset:8704
    ds_read_b64_tr_b16 a[36:37], v9 offset:8192
    ds_read_b64_tr_b16 a[38:39], v9 offset:8704
    ds_read_b64_tr_b16 a[40:41], v6 offset:10240
    ds_read_b64_tr_b16 a[42:43], v6 offset:10752
    ds_read_b64_tr_b16 a[44:45], v9 offset:10240
    ds_read_b64_tr_b16 a[46:47], v9 offset:10752
    ds_read_b64_tr_b16 a[48:49], v7 offset:0
    ds_read_b64_tr_b16 a[50:51], v7 offset:512
    ds_read_b64_tr_b16 a[52:53], v10 offset:0
    ds_read_b64_tr_b16 a[54:55], v10 offset:512
    ds_read_b64_tr_b16 a[56:57], v7 offset:2048
    ds_read_b64_tr_b16 a[58:59], v7 offset:2560
    ds_read_b64_tr_b16 a[60:61], v10 offset:2048
    ds_read_b64_tr_b16 a[62:63], v10 offset:2560
    ds_read_b64_tr_b16 a[64:65], v7 offset:4096
    ds_read_b64_tr_b16 a[66:67], v7 offset:4608
    ds_read_b64_tr_b16 a[68:69], v10 offset:4096
    ds_read_b64_tr_b16 a[70:71], v10 offset:4608
    ds_read_b64_tr_b16 a[72:73], v7 offset:6144
    ds_read_b64_tr_b16 a[74:75], v7 offset:6656
    ds_read_b64_tr_b16 a[76:77], v10 offset:6144
    ds_read_b64_tr_b16 a[78:79], v10 offset:6656
    ds_read_b64_tr_b16 a[80:81], v7 offset:8192
    ds_read_b64_tr_b16 a[82:83], v7 offset:8704
    ds_read_b64_tr_b16 a[84:85], v10 offset:8192
    ds_read_b64_tr_b16 a[86:87], v10 offset:8704
    ds_read_b64_tr_b16 a[88:89], v7 offset:10240
    ds_read_b64_tr_b16 a[90:91], v7 offset:10752
    ds_read_b64_tr_b16 a[92:93], v10 offset:10240
    ds_read_b64_tr_b16 a[94:95], v10 offset:10752
    ds_read_b64_tr_b16 a[96:97], v8 offset:0
    ds_read_b64_tr_b16 a[98:99], v8 offset:512
    ds_read_b64_tr_b16 a[100:101], v11 offset:0
    ds_read_b64_tr_b16 a[102:103], v11 offset:512
    ds_read_b64_tr_b16 a[104:105], v8 offset:2048
    ds_read_b64_tr_b16 a[106:107], v8 offset:2560
    ds_read_b64_tr_b16 a[108:109], v11 offset:2048
    ds_read_b64_tr_b16 a[110:111], v11 offset:2560
    ds_read_b64_tr_b16 a[112:113], v8 offset:4096
    ds_read_b64_tr_b16 a[114:115], v8 offset:4608
    ds_read_b64_tr_b16 a[116:117], v11 offset:4096
    ds_read_b64_tr_b16 a[118:119], v11 offset:4608
    ds_read_b64_tr_b16 a[120:121], v8 offset:6144
    ds_read_b64_tr_b16 a[122:123], v8 offset:6656
    ds_read_b64_tr_b16 a[124:125], v11 offset:6144
    ds_read_b64_tr_b16 a[126:127], v11 offset:6656
    v_lshlrev_b32 v48, 16, v164
    v_and_b32 v49, 0xffff0000, v164
    v_lshlrev_b32 v50, 16, v165
    v_and_b32 v51, 0xffff0000, v165
    v_lshlrev_b32 v52, 16, v166
    v_and_b32 v53, 0xffff0000, v166
    v_lshlrev_b32 v54, 16, v167
    v_and_b32 v55, 0xffff0000, v167
    v_lshlrev_b32 v56, 16, v168
    v_and_b32 v57, 0xffff0000, v168
    v_lshlrev_b32 v58, 16, v169
    v_and_b32 v59, 0xffff0000, v169
    v_lshlrev_b32 v60, 16, v170
    v_and_b32 v61, 0xffff0000, v170
    v_lshlrev_b32 v62, 16, v171
    v_and_b32 v63, 0xffff0000, v171
    s_waitcnt lgkmcnt(0)
    s_barrier
    s_and_b32 s4, s60, 8
    s_lshl_b32 s4, s4, 3
    v_add_u32 v8, s4, v29
    s_mov_b32 s16, 0
    s_mov_b64 exec, 255
L_poll0:
    buffer_load_dwordx2 v[6:7], v8, s[48:51], 0 offen offset:0 sc1
    s_waitcnt vmcnt(0)
    v_cmp_ne_u64 vcc, s[94:95], v[6:7]
    s_cbranch_vccz L_ok0
    s_add_u32 s16, s16, 1
    s_cmp_lt_u32 s16, 64
    s_cbranch_scc1 L_poll0
    s_cmp_eq_u32 s16, 64
    s_cbranch_scc0 L_pub0
    s_cmp_eq_u32 s56, 0
    s_cselect_b64 exec, 1, 0
    buffer_store_dwordx2 v[32:33], v30, s[48:51], 0 offen offset:512 sc1
    s_mov_b64 exec, 255
L_pub0:
    buffer_load_dwordx2 v[6:7], v8, s[48:51], 0 offen offset:512 sc1
    s_waitcnt vmcnt(0)
    v_cmp_ne_u64 vcc, s[94:95], v[6:7]
    s_cbranch_vccz L_ok0
    s_cmp_lt_u32 s16, 0x80000
    s_cbranch_scc1 L_poll0
L_ok0:
    s_mov_b64 exec, -1
    buffer_load_dwordx4 v[80:83], v12, s[48:51], 0 offen sc1
    buffer_load_dwordx4 v[84:87], v12, s[48:51], 0 offen offset:2048 sc1
    buffer_load_dwordx4 v[88:91], v12, s[48:51], s10 offen sc1
    buffer_load_dwordx4 v[92:95], v12, s[48:51], s10 offen offset:2048 sc1
    buffer_load_dwordx4 v[96:99], v12, s[48:51], s11 offen sc1
    buffer_load_dwordx4 v[100:103], v12, s[48:51], s11 offen offset:2048 sc1
    buffer_load_dwordx4 v[104:107], v12, s[48:51], s12 offen sc1
    buffer_load_dwordx4 v[108:111], v12, s[48:51], s12 offen offset:2048 sc1
    v_add_u32 v12, 16384, v12
    buffer_load_dwordx4 v[112:115], v12, s[48:51], 0 offen sc1
    buffer_load_dwordx4 v[116:119], v12, s[48:51], 0 offen offset:2048 sc1
    buffer_load_dwordx4 v[120:123], v12, s[48:51], s10 offen sc1
    buffer_load_dwordx4 v[124:127], v12, s[48:51], s10 offen offset:2048 sc1
    buffer_load_dwordx4 v[128:131], v12, s[48:51], s11 offen sc1
    buffer_load_dwordx4 v[132:135], v12, s[48:51], s11 offen offset:2048 sc1
    buffer_load_dwordx4 v[136:139], v12, s[48:51], s12 offen sc1
    buffer_load_dwordx4 v[140:143], v12, s[48:51], s12 offen offset:2048 sc1
    s_waitcnt vmcnt(15)
    v_mfma_f32_32x32x16_bf16 v[48:63], a[0:3], v[80:83], v[48:63]
    s_add_u32 m0, s21, 65536
    s_add_u32 s9, s27, 0
    v_mfma_f32_32x32x16_bf16 v[64:79], a[4:7], v[80:83], 0
    buffer_load_dwordx4 v18, s[40:43], s9 offen lds
    s_waitcnt vmcnt(15)
    v_mfma_f32_32x32x16_bf16 v[48:63], a[8:11], v[84:87], v[48:63]
    v_mfma_f32_32x32x16_bf16 v[64:79], a[12:15], v[84:87], v[64:79]
    buffer_load_dwordx4 v19, s[40:43], s9 offen offset:1024 lds
    s_waitcnt vmcnt(15)
    v_mfma_f32_32x32x16_bf16 v[48:63], a[16:19], v[88:91], v[48:63]
    v_mfma_f32_32x32x16_bf16 v[64:79], a[20:23], v[88:91], v[64:79]
    buffer_load_dwordx4 v20, s[40:43], s9 offen offset:2048 lds
    s_waitcnt vmcnt(15)
    v_mfma_f32_32x32x16_bf16 v[48:63], a[24:27], v[92:95], v[48:63]
    v_mfma_f32_32x32x16_bf16 v[64:79], a[28:31], v[92:95], v[64:79]
    buffer_load_dwordx4 v21, s[40:43], s9 offen offset:3072 lds
    s_waitcnt vmcnt(15)
    v_mfma_f32_32x32x16_bf16 v[48:63], a[32:35], v[96:99], v[48:63]
    s_add_u32 m0, s21, 69632
    s_add_u32 s9, s27, 114688
    v_mfma_f32_32x32x16_bf16 v[64:79], a[36:39], v[96:99], v[64:79]
    buffer_load_dwordx4 v18, s[40:43], s9 offen lds
    s_waitcnt vmcnt(15)
    v_mfma_f32_32x32x16_bf16 v[48:63], a[40:43], v[100:103], v[48:63]
    v_mfma_f32_32x32x16_bf16 v[64:79], a[44:47], v[100:103], v[64:79]
    buffer_load_dwordx4 v19, s[40:43], s9 offen offset:1024 lds
    s_waitcnt vmcnt(15)
    v_mfma_f32_32x32x16_bf16 v[48:63], a[48:51], v[104:107], v[48:63]
    v_mfma_f32_32x32x16_bf16 v[64:79], a[52:55], v[104:107], v[64:79]
    buffer_load_dwordx4 v20, s[40:43], s9 offen offset:2048 lds
    s_waitcnt vmcnt(15)
    v_mfma_f32_32x32x16_bf16 v[48:63], a[56:59], v[108:111], v[48:63]
    v_mfma_f32_32x32x16_bf16 v[64:79], a[60:63], v[108:111], v[64:79]
    buffer_load_dwordx4 v21, s[40:43], s9 offen offset:3072 lds
    s_waitcnt vmcnt(15)
    v_mfma_f32_32x32x16_bf16 v[48:63], a[64:67], v[112:115], v[48:63]
    s_add_u32 m0, s21, 73728
    s_add_u32 s9, s27, 229376
    v_mfma_f32_32x32x16_bf16 v[64:79], a[68:71], v[112:115], v[64:79]
    buffer_load_dwordx4 v18, s[40:43], s9 offen lds
    s_waitcnt vmcnt(15)
    v_mfma_f32_32x32x16_bf16 v[48:63], a[72:75], v[116:119], v[48:63]
    v_mfma_f32_32x32x16_bf16 v[64:79], a[76:79], v[116:119], v[64:79]
    buffer_load_dwordx4 v19, s[40:43], s9 offen offset:1024 lds
    s_waitcnt vmcnt(15)
    v_mfma_f32_32x32x16_bf16 v[48:63], a[80:83], v[120:123], v[48:63]
    v_mfma_f32_32x32x16_bf16 v[64:79], a[84:87], v[120:123], v[64:79]
    buffer_load_dwordx4 v20, s[40:43], s9 offen offset:2048 lds
    s_waitcnt vmcnt(15)
    v_mfma_f32_32x32x16_bf16 v[48:63], a[88:91], v[124:127], v[48:63]
    v_mfma_f32_32x32x16_bf16 v[64:79], a[92:95], v[124:127], v[64:79]
    buffer_load_dwordx4 v21, s[40:43], s9 offen offset:3072 lds
    s_waitcnt vmcnt(15)
    v_mfma_f32_32x32x16_bf16 v[48:63], a[96:99], v[128:131], v[48:63]
    s_add_u32 m0, s21, 77824
    s_add_u32 s9, s27, 344064
    v_mfma_f32_32x32x16_bf16 v[64:79], a[100:103], v[128:131], v[64:79]
    buffer_load_dwordx4 v18, s[40:43], s9 offen lds
    s_waitcnt vmcnt(15)
    v_mfma_f32_32x32x16_bf16 v[48:63], a[104:107], v[132:135], v[48:63]
    v_mfma_f32_32x32x16_bf16 v[64:79], a[108:111], v[132:135], v[64:79]
    buffer_load_dwordx4 v19, s[40:43], s9 offen offset:1024 lds
    s_waitcnt vmcnt(15)
    v_mfma_f32_32x32x16_bf16 v[48:63], a[112:115], v[136:139], v[48:63]
    v_mfma_f32_32x32x16_bf16 v[64:79], a[116:119], v[136:139], v[64:79]
    buffer_load_dwordx4 v20, s[40:43], s9 offen offset:2048 lds
    s_waitcnt vmcnt(15)
    v_mfma_f32_32x32x16_bf16 v[48:63], a[120:123], v[140:143], v[48:63]
    v_mfma_f32_32x32x16_bf16 v[64:79], a[124:127], v[140:143], v[64:79]
    buffer_load_dwordx4 v21, s[40:43], s9 offen offset:3072 lds
    s_cmp_eq_u32 s56, 0
    s_cselect_b64 exec, 1, 0
    buffer_store_dwordx2 v[32:33], v30, s[48:51], 0 offen offset:512 sc1
    s_mov_b64 exec, -1
    s_nop 6
    ds_write_b128 v16, v[64:67] offset:0
    ds_write_b128 v16, v[68:71] offset:1024
    ds_write_b128 v16, v[72:75] offset:2048
    ds_write_b128 v16, v[76:79] offset:3072
    s_waitcnt lgkmcnt(0)
    s_barrier
    ds_read_b128 v[64:67], v17 offset:0
    ds_read_b128 v[68:71], v17 offset:1024
    ds_read_b128 v[72:75], v17 offset:2048
    ds_read_b128 v[76:79], v17 offset:3072
    s_waitcnt lgkmcnt(3)
    v_pk_add_f32 v[48:49], v[48:49], v[64:65]
    v_pk_add_f32 v[50:51], v[50:51], v[66:67]
    s_waitcnt lgkmcnt(2)
    v_pk_add_f32 v[52:53], v[52:53], v[68:69]
    v_pk_add_f32 v[54:55], v[54:55], v[70:71]
    s_waitcnt lgkmcnt(1)
    v_pk_add_f32 v[56:57], v[56:57], v[72:73]
    v_pk_add_f32 v[58:59], v[58:59], v[74:75]
    s_waitcnt lgkmcnt(0)
    v_pk_add_f32 v[60:61], v[60:61], v[76:77]
    v_pk_add_f32 v[62:63], v[62:63], v[78:79]
    v_cvt_pk_bf16_f32 v164, v48, v49
    v_cvt_pk_bf16_f32 v165, v50, v51
    v_cvt_pk_bf16_f32 v166, v52, v53
    v_cvt_pk_bf16_f32 v167, v54, v55
    v_cvt_pk_bf16_f32 v168, v56, v57
    v_cvt_pk_bf16_f32 v169, v58, v59
    v_cvt_pk_bf16_f32 v170, v60, v61
    v_cvt_pk_bf16_f32 v171, v62, v63
    buffer_store_dwordx4 v[164:167], v26, s[48:51], 0 offen sc1
    buffer_store_dwordx4 v[168:171], v26, s[48:51], 0 offen offset:2048 sc1
    v_mov_b32 v6, 0
    v_mov_b32 v7, 0
    v_dot2c_f32_bf16 v6, v164, v2
    v_dot2c_f32_bf16 v7, v164, v164
    v_dot2c_f32_bf16 v6, v165, v2
    v_dot2c_f32_bf16 v7, v165, v165
    v_dot2c_f32_bf16 v6, v166, v2
    v_dot2c_f32_bf16 v7, v166, v166
    v_dot2c_f32_bf16 v6, v167, v2
    v_dot2c_f32_bf16 v7, v167, v167
    v_dot2c_f32_bf16 v6, v168, v2
    v_dot2c_f32_bf16 v7, v168, v168
    v_dot2c_f32_bf16 v6, v169, v2
    v_dot2c_f32_bf16 v7, v169, v169
    v_dot2c_f32_bf16 v6, v170, v2
    v_dot2c_f32_bf16 v7, v170, v170
    v_dot2c_f32_bf16 v6, v171, v2
    v_dot2c_f32_bf16 v7, v171, v171
    v_mov_b32 v8, v6
    v_mov_b32 v9, v7
    s_nop 0
    v_permlane32_swap_b32 v6, v8
    v_permlane32_swap_b32 v7, v9
    v_add_f32 v6, v6, v8
    v_add_f32 v7, v7, v9
    s_mov_b32 exec_hi, 0
    buffer_store_dwordx2 v[6:7], v27, s[48:51], 0 offen sc1
    s_mov_b64 exec, -1
    v_bfe_u32 v10, v0, 2, 2
    v_lshrrev_b32 v11, 5, v0
    v_lshl_add_u32 v10, v11, 2, v10
    v_lshlrev_b32 v10, 7, v10
    v_bfe_u32 v11, v0, 3, 1
    v_lshl_add_u32 v10, v11, 6, v10
    v_bfe_u32 v11, v0, 4, 1
    v_lshl_add_u32 v10, v11, 5, v10
    v_and_b32 v11, 3, v0
    v_lshl_add_u32 v6, v11, 3, v10
    v_xor_b32 v7, 64, v6
    v_add_u32 v8, 65536, v6
    v_add_u32 v9, 65536, v7
    v_mov_b32 v12, v6
    s_lshl_b32 s4, s69, 6
    v_xor_b32 v28, s4, v12
    v_add_u32 v13, s20, v28
    v_add_u32 v16, s21, v28
    v_add_u32 v26, s22, v28
    v_xor_b32 v28, 64, v28
    v_add_u32 v14, s20, v28
    v_add_u32 v17, s21, v28
    v_add_u32 v27, s22, v28
    s_lshl_b32 s4, s70, 6
    s_lshl_b32 s5, s69, 16
    v_xor_b32 v12, s4, v6
    v_add_u32 v12, s5, v12
    v_lshrrev_b32 v10, 4, v0
    v_xor_b32 v10, v10, v0
    v_and_b32 v10, 1, v10
    v_cmp_eq_u32 vcc, 0, v10
    v_mov_b32 v11, 0
    s_nop 0
    v_cndmask_b32 v48, v11, v2, vcc
    v_cndmask_b32 v49, v11, v2, vcc
    v_cndmask_b32 v50, v11, v2, vcc
    v_cndmask_b32 v51, v11, v2, vcc
    s_lshl_b32 s4, s61, 2
    s_add_u32 s4, s4, s56
    s_lshl_b32 s5, s4, 16
    s_add_u32 s5, s5, 4194304
    v_add_u32 v28, s5, v15
    s_mul_i32 s5, s4, 229376
    s_lshl_b32 s6, s71, 14
    s_add_u32 s5, s5, s6
    s_add_u32 s5, s5, 10485760
    v_add_u32 v34, s5, v15
    s_lshl_b32 s6, s27, 6
    v_add_u32 v53, s6, v34
    s_lshl_b32 s6, s26, 6
    v_add_u32 v34, s6, v34
    s_lshl_b32 s5, s4, 13
    s_add_u32 s5, s5, 8388608
    v_and_b32 v11, 31, v0
    v_lshlrev_b32 v11, 3, v11
    v_lshrrev_b32 v31, 5, v0
    v_lshl_add_u32 v31, v31, 9, v11
    v_add_u32 v31, s5, v31
    v_and_b32 v10, 15, v0
    v_lshlrev_b32 v10, 2, v10
    s_lshl_b32 s4, s56, 7
    s_add_u32 s4, s4, 159744
    v_add_u32 v35, s4, v10
    v_and_b32 v10, 31, v0
    v_lshlrev_b32 v10, 2, v10
    v_add_u32 v52, 159744, v10
    s_waitcnt vmcnt(0)
    s_barrier
    s_cmp_eq_u32 s56, 0
    s_cselect_b64 exec, 1, 0
    buffer_store_dwordx2 v[32:33], v30, s[48:51], 0 offen offset:128
    s_mov_b64 exec, -1
    ds_read_b64_tr_b16 v[58:59], v12 offset:0
    ds_read_b64_tr_b16 v[60:61], v12 offset:1024
    ds_read_b64_tr_b16 v[62:63], v12 offset:2048
    ds_read_b64_tr_b16 v[64:65], v12 offset:3072
    ds_read_b64_tr_b16 v[66:67], v12 offset:4096
    ds_read_b64_tr_b16 v[68:69], v12 offset:5120
    ds_read_b64_tr_b16 v[70:71], v12 offset:6144
    ds_read_b64_tr_b16 v[72:73], v12 offset:7168
    ds_read_b64_tr_b16 v[74:75], v12 offset:8192
    ds_read_b64_tr_b16 v[76:77], v12 offset:9216
    ds_read_b64_tr_b16 v[78:79], v12 offset:10240
    ds_read_b64_tr_b16 v[80:81], v12 offset:11264
    s_waitcnt lgkmcnt(10)
    v_mfma_f32_16x16x32_bf16 v[54:57], v[48:51], v[58:61], 0
    ds_read_b64_tr_b16 v[82:83], v12 offset:12288
    ds_read_b64_tr_b16 v[84:85], v12 offset:13312
    s_waitcnt lgkmcnt(10)
    v_mfma_f32_16x16x32_bf16 v[54:57], v[48:51], v[62:65], v[54:57]
    ds_read_b64_tr_b16 v[86:87], v12 offset:14336
    ds_read_b64_tr_b16 v[88:89], v12 offset:15360
    s_waitcnt lgkmcnt(10)
    v_mfma_f32_16x16x32_bf16 v[54:57], v[48:51], v[66:69], v[54:57]
    ds_read_b64_tr_b16 v[58:59], v12 offset:16384
    ds_read_b64_tr_b16 v[60:61], v12 offset:17408
    s_waitcnt lgkmcnt(10)
    v_mfma_f32_16x16x32_bf16 v[54:57], v[48:51], v[70:73], v[54:57]
    ds_read_b64_tr_b16 v[62:63], v12 offset:18432
    ds_read_b64_tr_b16 v[64:65], v12 offset:19456
    s_waitcnt lgkmcnt(10)
    v_mfma_f32_16x16x32_bf16 v[54:57], v[48:51], v[74:77], v[54:57]
    ds_read_b64_tr_b16 v[66:67], v12 offset:20480
    ds_read_b64_tr_b16 v[68:69], v12 offset:21504
    s_waitcnt lgkmcnt(10)
    v_mfma_f32_16x16x32_bf16 v[54:57], v[48:51], v[78:81], v[54:57]
    ds_read_b64_tr_b16 v[70:71], v12 offset:22528
    ds_read_b64_tr_b16 v[72:73], v12 offset:23552
    s_waitcnt lgkmcnt(10)
    v_mfma_f32_16x16x32_bf16 v[54:57], v[48:51], v[82:85], v[54:57]
    ds_read_b64_tr_b16 v[74:75], v12 offset:24576
    ds_read_b64_tr_b16 v[76:77], v12 offset:25600
    s_waitcnt lgkmcnt(10)
    v_mfma_f32_16x16x32_bf16 v[54:57], v[48:51], v[86:89], v[54:57]
    ds_read_b64_tr_b16 v[78:79], v12 offset:26624
    ds_read_b64_tr_b16 v[80:81], v12 offset:27648
    s_waitcnt lgkmcnt(10)
    v_mfma_f32_16x16x32_bf16 v[54:57], v[48:51], v[58:61], v[54:57]
    ds_read_b64_tr_b16 v[82:83], v12 offset:28672
    ds_read_b64_tr_b16 v[84:85], v12 offset:29696
    s_waitcnt lgkmcnt(10)
    v_mfma_f32_16x16x32_bf16 v[54:57], v[48:51], v[62:65], v[54:57]
    ds_read_b64_tr_b16 v[86:87], v12 offset:30720
    ds_read_b64_tr_b16 v[88:89], v12 offset:31744
    s_waitcnt lgkmcnt(10)
    v_mfma_f32_16x16x32_bf16 v[54:57], v[48:51], v[66:69], v[54:57]
    ds_read_b64_tr_b16 v[58:59], v12 offset:32768
    ds_read_b64_tr_b16 v[60:61], v12 offset:33792
    s_waitcnt lgkmcnt(10)
    v_mfma_f32_16x16x32_bf16 v[54:57], v[48:51], v[70:73], v[54:57]
    ds_read_b64_tr_b16 v[62:63], v12 offset:34816
    ds_read_b64_tr_b16 v[64:65], v12 offset:35840
    s_waitcnt lgkmcnt(10)
    v_mfma_f32_16x16x32_bf16 v[54:57], v[48:51], v[74:77], v[54:57]
    ds_read_b64_tr_b16 v[66:67], v12 offset:36864
    ds_read_b64_tr_b16 v[68:69], v12 offset:37888
    s_waitcnt lgkmcnt(10)
    v_mfma_f32_16x16x32_bf16 v[54:57], v[48:51], v[78:81], v[54:57]
    ds_read_b64_tr_b16 v[70:71], v12 offset:38912
    ds_read_b64_tr_b16 v[72:73], v12 offset:39936
    s_waitcnt lgkmcnt(10)
    v_mfma_f32_16x16x32_bf16 v[54:57], v[48:51], v[82:85], v[54:57]
    ds_read_b64_tr_b16 v[74:75], v12 offset:40960
    ds_read_b64_tr_b16 v[76:77], v12 offset:41984
    s_waitcnt lgkmcnt(10)
    v_mfma_f32_16x16x32_bf16 v[54:57], v[48:51], v[86:89], v[54:57]
    ds_read_b64_tr_b16 v[78:79], v12 offset:43008
    ds_read_b64_tr_b16 v[80:81], v12 offset:44032
    s_waitcnt lgkmcnt(10)
    v_mfma_f32_16x16x32_bf16 v[54:57], v[48:51], v[58:61], v[54:57]
    ds_read_b64_tr_b16 v[82:83], v12 offset:45056
    ds_read_b64_tr_b16 v[84:85], v12 offset:46080
    s_waitcnt lgkmcnt(10)
    v_mfma_f32_16x16x32_bf16 v[54:57], v[48:51], v[62:65], v[54:57]
    ds_read_b64_tr_b16 v[86:87], v12 offset:47104
    ds_read_b64_tr_b16 v[88:89], v12 offset:48128
    s_waitcnt lgkmcnt(10)
    v_mfma_f32_16x16x32_bf16 v[54:57], v[48:51], v[66:69], v[54:57]
    ds_read_b64_tr_b16 v[58:59], v12 offset:49152
    ds_read_b64_tr_b16 v[60:61], v12 offset:50176
    s_waitcnt lgkmcnt(10)
    v_mfma_f32_16x16x32_bf16 v[54:57], v[48:51], v[70:73], v[54:57]
    ds_read_b64_tr_b16 v[62:63], v12 offset:51200
    ds_read_b64_tr_b16 v[64:65], v12 offset:52224
    s_waitcnt lgkmcnt(10)
    v_mfma_f32_16x16x32_bf16 v[54:57], v[48:51], v[74:77], v[54:57]
    ds_read_b64_tr_b16 v[66:67], v12 offset:53248
    ds_read_b64_tr_b16 v[68:69], v12 offset:54272
    s_waitcnt lgkmcnt(10)
    v_mfma_f32_16x16x32_bf16 v[54:57], v[48:51], v[78:81], v[54:57]
    ds_read_b64_tr_b16 v[70:71], v12 offset:55296
    ds_read_b64_tr_b16 v[72:73], v12 offset:56320
    s_waitcnt lgkmcnt(10)
    v_mfma_f32_16x16x32_bf16 v[54:57], v[48:51], v[82:85], v[54:57]
    ds_read_b64_tr_b16 v[74:75], v12 offset:57344
    ds_read_b64_tr_b16 v[76:77], v12 offset:58368
    s_waitcnt lgkmcnt(10)
    v_mfma_f32_16x16x32_bf16 v[54:57], v[48:51], v[86:89], v[54:57]
    ds_read_b64_tr_b16 v[78:79], v12 offset:59392
    ds_read_b64_tr_b16 v[80:81], v12 offset:60416
    s_waitcnt lgkmcnt(10)
    v_mfma_f32_16x16x32_bf16 v[54:57], v[48:51], v[58:61], v[54:57]
    ds_read_b64_tr_b16 v[82:83], v12 offset:61440
    ds_read_b64_tr_b16 v[84:85], v12 offset:62464
    s_waitcnt lgkmcnt(10)
    v_mfma_f32_16x16x32_bf16 v[54:57], v[48:51], v[62:65], v[54:57]
    ds_read_b64_tr_b16 v[86:87], v12 offset:63488
    ds_read_b64_tr_b16 v[88:89], v12 offset:64512
    s_waitcnt lgkmcnt(10)
    v_mfma_f32_16x16x32_bf16 v[54:57], v[48:51], v[66:69], v[54:57]
    s_waitcnt lgkmcnt(8)
    v_mfma_f32_16x16x32_bf16 v[54:57], v[48:51], v[70:73], v[54:57]
    s_waitcnt lgkmcnt(6)
    v_mfma_f32_16x16x32_bf16 v[54:57], v[48:51], v[74:77], v[54:57]
    s_waitcnt lgkmcnt(4)
    v_mfma_f32_16x16x32_bf16 v[54:57], v[48:51], v[78:81], v[54:57]
    s_waitcnt lgkmcnt(2)
    v_mfma_f32_16x16x32_bf16 v[54:57], v[48:51], v[82:85], v[54:57]
    s_waitcnt lgkmcnt(0)
    v_mfma_f32_16x16x32_bf16 v[54:57], v[48:51], v[86:89], v[54:57]
    s_nop 7
    ds_write_b32 v35, v54
    ds_write_b32 v35, v55 offset:64
    s_waitcnt lgkmcnt(0)
    s_barrier
    ds_read_b32 v66, v52 offset:0
    ds_read_b32 v67, v52 offset:128
    ds_read_b32 v68, v52 offset:256
    ds_read_b32 v69, v52 offset:384
    s_waitcnt lgkmcnt(3)
    v_cvt_pk_bf16_f32 v48, v66, v66
    v_lshl_or_b32 v50, v36, 16, v36
    v_and_b32 v10, 0xffff0000, v48
    v_mov_b32 v51, 0
    v_sub_f32 v11, v66, v10
    v_cvt_pk_bf16_f32 v49, v11, v11
    s_waitcnt lgkmcnt(2)
    v_cvt_pk_bf16_f32 v54, v67, v67
    v_lshl_or_b32 v56, v37, 16, v37
    v_and_b32 v10, 0xffff0000, v54
    v_mov_b32 v57, 0
    v_sub_f32 v11, v67, v10
    v_cvt_pk_bf16_f32 v55, v11, v11
    s_waitcnt lgkmcnt(1)
    v_cvt_pk_bf16_f32 v58, v68, v68
    v_lshl_or_b32 v60, v38, 16, v38
    v_and_b32 v10, 0xffff0000, v58
    v_mov_b32 v61, 0
    v_sub_f32 v11, v68, v10
    v_cvt_pk_bf16_f32 v59, v11, v11
    s_waitcnt lgkmcnt(0)
    v_cvt_pk_bf16_f32 v62, v69, v69
    v_lshl_or_b32 v64, v39, 16, v39
    v_and_b32 v10, 0xffff0000, v62
    v_mov_b32 v65, 0
    v_sub_f32 v11, v69, v10
    v_cvt_pk_bf16_f32 v63, v11, v11
    s_cmp_eq_u32 s58, 3
    s_cbranch_scc1 L_idle3
    ds_read_b64_tr_b16 v[36:37], v6 offset:0
    ds_read_b64_tr_b16 v[38:39], v6 offset:1024
    ds_read_b64_tr_b16 v[130:131], v7 offset:0
    ds_read_b64_tr_b16 v[132:133], v7 offset:1024
    ds_read_b64_tr_b16 v[134:135], v6 offset:2048
    ds_read_b64_tr_b16 v[136:137], v6 offset:3072
    ds_read_b64_tr_b16 v[138:139], v7 offset:2048
    ds_read_b64_tr_b16 v[140:141], v7 offset:3072
    v_mov_b32 v12, v29
    s_mov_b32 s16, 0
    s_mov_b64 exec, 65535
L_poll1:
    buffer_load_dwordx2 v[150:151], v12, s[48:51], 0 offen offset:128 sc1
    s_waitcnt vmcnt(0)
    v_cmp_ne_u64 vcc, s[94:95], v[150:151]
    s_cbranch_vccz L_ok1
    s_add_u32 s16, s16, 1
    s_cmp_lt_u32 s16, 64
    s_cbranch_scc1 L_poll1
    s_cmp_eq_u32 s16, 64
    s_cbranch_scc0 L_pub1
    s_cmp_eq_u32 s56, 0
    s_cselect_b64 exec, 1, 0
    buffer_store_dwordx2 v[32:33], v30, s[48:51], 0 offen offset:640 sc1
    s_mov_b64 exec, 65535
L_pub1:
    buffer_load_dwordx2 v[150:151], v12, s[48:51], 0 offen offset:640 sc1
    s_waitcnt vmcnt(0)
    v_cmp_ne_u64 vcc, s[94:95], v[150:151]
    s_cbranch_vccz L_ok1
    s_cmp_lt_u32 s16, 0x80000
    s_cbranch_scc1 L_poll1
L_ok1:
    s_mov_b64 exec, -1
    s_mov_b32 s8, 0
    buffer_load_dwordx4 a[0:3], v28, s[48:51], s8 offen sc1
    buffer_load_dwordx4 a[4:7], v28, s[48:51], s8 offen offset:2048 sc1
    buffer_load_dwordx2 v[172:173], v31, s[48:51], 0 offen offset:0 sc1
    buffer_load_dwordx2 v[174:175], v31, s[48:51], 0 offen offset:1024 sc1
    buffer_load_dwordx2 v[176:177], v31, s[48:51], 0 offen offset:2048 sc1
    buffer_load_dwordx2 v[178:179], v31, s[48:51], 0 offen offset:3072 sc1
    buffer_load_dwordx2 v[180:181], v31, s[48:51], s10 offen offset:0 sc1
    buffer_load_dwordx2 v[182:183], v31, s[48:51], s10 offen offset:1024 sc1
    buffer_load_dwordx2 v[184:185], v31, s[48:51], s10 offen offset:2048 sc1
    buffer_load_dwordx2 v[186:187], v31, s[48:51], s10 offen offset:3072 sc1
    s_mov_b32 s8, 4096
    buffer_load_dwordx4 a[8:11], v28, s[48:51], s8 offen sc1
    buffer_load_dwordx4 a[12:15], v28, s[48:51], s8 offen offset:2048 sc1
    s_mov_b32 s8, 8192
    buffer_load_dwordx4 a[16:19], v28, s[48:51], s8 offen sc1
    buffer_load_dwordx4 a[20:23], v28, s[48:51], s8 offen offset:2048 sc1
    s_mov_b32 s8, 12288
    buffer_load_dwordx4 a[24:27], v28, s[48:51], s8 offen sc1
    buffer_load_dwordx4 a[28:31], v28, s[48:51], s8 offen offset:2048 sc1
    s_mov_b32 s8, 16384
    buffer_load_dwordx4 a[32:35], v28, s[48:51], s8 offen sc1
    buffer_load_dwordx4 a[36:39], v28, s[48:51], s8 offen offset:2048 sc1
    s_mov_b32 s8, 20480
    buffer_load_dwordx4 a[40:43], v28, s[48:51], s8 offen sc1
    buffer_load_dwordx4 a[44:47], v28, s[48:51], s8 offen offset:2048 sc1
    s_mov_b32 s8, 24576
    buffer_load_dwordx4 a[48:51], v28, s[48:51], s8 offen sc1
    buffer_load_dwordx4 a[52:55], v28, s[48:51], s8 offen offset:2048 sc1
    s_waitcnt vmcnt(21) lgkmcnt(6)
    v_mfma_f32_32x32x16_bf16 v[66:81], v[36:39], a[0:3], 0
    s_mov_b32 s8, 28672
    buffer_load_dwordx4 a[56:59], v28, s[48:51], s8 offen sc1
    ds_read_b64_tr_b16 v[142:143], v6 offset:4096
    ds_read_b64_tr_b16 v[144:145], v6 offset:5120
    s_waitcnt lgkmcnt(6)
    v_mfma_f32_32x32x16_bf16 v[82:97], v[130:133], a[0:3], 0
    ds_read_b64_tr_b16 v[146:147], v7 offset:4096
    ds_read_b64_tr_b16 v[148:149], v7 offset:5120
    ds_read_b64_tr_b16 a[128:129], v8 offset:0
    ds_read_b64_tr_b16 a[130:131], v8 offset:1024
    s_waitcnt vmcnt(21) lgkmcnt(8)
    v_mfma_f32_32x32x16_bf16 v[66:81], v[134:137], a[4:7], v[66:81]
    buffer_load_dwordx4 a[60:63], v28, s[48:51], s8 offen offset:2048 sc1
    ds_read_b64_tr_b16 v[36:37], v6 offset:6144
    ds_read_b64_tr_b16 v[38:39], v6 offset:7168
    s_waitcnt lgkmcnt(8)
    v_mfma_f32_32x32x16_bf16 v[82:97], v[138:141], a[4:7], v[82:97]
    ds_read_b64_tr_b16 v[130:131], v7 offset:6144
    ds_read_b64_tr_b16 v[132:133], v7 offset:7168
    ds_read_b64_tr_b16 a[132:133], v8 offset:2048
    ds_read_b64_tr_b16 a[134:135], v8 offset:3072
    s_waitcnt vmcnt(13) lgkmcnt(10)
    v_mfma_f32_32x32x16_bf16 v[66:81], v[142:145], a[8:11], v[66:81]
    s_mov_b32 s8, 32768
    buffer_load_dwordx4 a[64:67], v28, s[48:51], s8 offen sc1
    ds_read_b64_tr_b16 v[134:135], v6 offset:8192
    ds_read_b64_tr_b16 v[136:137], v6 offset:9216
    s_waitcnt lgkmcnt(10)
    v_mfma_f32_32x32x16_bf16 v[82:97], v[146:149], a[8:11], v[82:97]
    ds_read_b64_tr_b16 v[138:139], v7 offset:8192
    ds_read_b64_tr_b16 v[140:141], v7 offset:9216
    ds_read_b64_tr_b16 a[136:137], v8 offset:4096
    ds_read_b64_tr_b16 a[138:139], v8 offset:5120
    s_waitcnt vmcnt(13) lgkmcnt(10)
    v_mfma_f32_32x32x16_bf16 v[66:81], v[36:39], a[12:15], v[66:81]
    buffer_load_dwordx4 a[68:71], v28, s[48:51], s8 offen offset:2048 sc1
    ds_read_b64_tr_b16 v[142:143], v6 offset:10240
    ds_read_b64_tr_b16 v[144:145], v6 offset:11264
    s_waitcnt lgkmcnt(10)
    v_mfma_f32_32x32x16_bf16 v[82:97], v[130:133], a[12:15], v[82:97]
    ds_read_b64_tr_b16 v[146:147], v7 offset:10240
    ds_read_b64_tr_b16 v[148:149], v7 offset:11264
    ds_read_b64_tr_b16 a[140:141], v8 offset:6144
    ds_read_b64_tr_b16 a[142:143], v8 offset:7168
    s_waitcnt vmcnt(13) lgkmcnt(10)
    v_mfma_f32_32x32x16_bf16 v[66:81], v[134:137], a[16:19], v[66:81]
    s_mov_b32 s8, 36864
    buffer_load_dwordx4 a[72:75], v28, s[48:51], s8 offen sc1
    ds_read_b64_tr_b16 v[36:37], v6 offset:12288
    ds_read_b64_tr_b16 v[38:39], v6 offset:13312
    v_add_f32 v172, v172, v174
    s_waitcnt lgkmcnt(10)
    v_mfma_f32_32x32x16_bf16 v[82:97], v[138:141], a[16:19], v[82:97]
    ds_read_b64_tr_b16 v[130:131], v7 offset:12288
    ds_read_b64_tr_b16 v[132:133], v7 offset:13312
    ds_read_b64_tr_b16 a[144:145], v8 offset:8192
    ds_read_b64_tr_b16 a[146:147], v8 offset:9216
    v_add_f32 v173, v173, v175
    s_waitcnt vmcnt(13) lgkmcnt(10)
    v_mfma_f32_32x32x16_bf16 v[66:81], v[142:145], a[20:23], v[66:81]
    buffer_load_dwordx4 a[76:79], v28, s[48:51], s8 offen offset:2048 sc1
    ds_read_b64_tr_b16 v[134:135], v6 offset:14336
    ds_read_b64_tr_b16 v[136:137], v6 offset:15360
    v_add_f32 v172, v172, v176
    v_add_f32 v173, v173, v177
    s_waitcnt lgkmcnt(10)
    v_mfma_f32_32x32x16_bf16 v[82:97], v[146:149], a[20:23], v[82:97]
    ds_read_b64_tr_b16 v[138:139], v7 offset:14336
    ds_read_b64_tr_b16 v[140:141], v7 offset:15360
    ds_read_b64_tr_b16 a[148:149], v8 offset:10240
    ds_read_b64_tr_b16 a[150:151], v8 offset:11264
    v_add_f32 v172, v172, v178
    s_waitcnt vmcnt(13) lgkmcnt(10)
    v_mfma_f32_32x32x16_bf16 v[66:81], v[36:39], a[24:27], v[66:81]
    s_mov_b32 s8, 40960
    buffer_load_dwordx4 a[80:83], v28, s[48:51], s8 offen sc1
    ds_read_b64_tr_b16 v[142:143], v6 offset:16384
    ds_read_b64_tr_b16 v[144:145], v6 offset:17408
    v_add_f32 v173, v173, v179
    s_waitcnt lgkmcnt(10)
    v_mfma_f32_32x32x16_bf16 v[82:97], v[130:133], a[24:27], v[82:97]
    ds_read_b64_tr_b16 v[146:147], v7 offset:16384
    ds_read_b64_tr_b16 v[148:149], v7 offset:17408
    ds_read_b64_tr_b16 a[152:153], v8 offset:12288
    ds_read_b64_tr_b16 a[154:155], v8 offset:13312
    v_add_f32 v172, v172, v180
    s_waitcnt vmcnt(13) lgkmcnt(10)
    v_mfma_f32_32x32x16_bf16 v[66:81], v[134:137], a[28:31], v[66:81]
    buffer_load_dwordx4 a[84:87], v28, s[48:51], s8 offen offset:2048 sc1
    ds_read_b64_tr_b16 v[36:37], v6 offset:18432
    ds_read_b64_tr_b16 v[38:39], v6 offset:19456
    v_add_f32 v173, v173, v181
    v_add_f32 v172, v172, v182
    s_waitcnt lgkmcnt(10)
    v_mfma_f32_32x32x16_bf16 v[82:97], v[138:141], a[28:31], v[82:97]
    ds_read_b64_tr_b16 v[130:131], v7 offset:18432
    ds_read_b64_tr_b16 v[132:133], v7 offset:19456
    ds_read_b64_tr_b16 a[156:157], v8 offset:14336
    ds_read_b64_tr_b16 a[158:159], v8 offset:15360
    v_add_f32 v173, v173, v183
    s_waitcnt vmcnt(13) lgkmcnt(10)
    v_mfma_f32_32x32x16_bf16 v[66:81], v[142:145], a[32:35], v[66:81]
    s_mov_b32 s8, 45056
    buffer_load_dwordx4 a[88:91], v28, s[48:51], s8 offen sc1
    ds_read_b64_tr_b16 v[134:135], v6 offset:20480
    ds_read_b64_tr_b16 v[136:137], v6 offset:21504
    v_add_f32 v172, v172, v184
    s_waitcnt lgkmcnt(10)
    v_mfma_f32_32x32x16_bf16 v[82:97], v[146:149], a[32:35], v[82:97]
    ds_read_b64_tr_b16 v[138:139], v7 offset:20480
    ds_read_b64_tr_b16 v[140:141], v7 offset:21504
    ds_read_b64_tr_b16 a[160:161], v8 offset:16384
    ds_read_b64_tr_b16 a[162:163], v8 offset:17408
    v_add_f32 v173, v173, v185
    s_waitcnt vmcnt(13) lgkmcnt(10)
    v_mfma_f32_32x32x16_bf16 v[66:81], v[36:39], a[36:39], v[66:81]
    buffer_load_dwordx4 a[92:95], v28, s[48:51], s8 offen offset:2048 sc1
    ds_read_b64_tr_b16 v[142:143], v6 offset:22528
    ds_read_b64_tr_b16 v[144:145], v6 offset:23552
    v_add_f32 v172, v172, v186
    v_add_f32 v173, v173, v187
    s_waitcnt lgkmcnt(10)
    v_mfma_f32_32x32x16_bf16 v[82:97], v[130:133], a[36:39], v[82:97]
    ds_read_b64_tr_b16 v[146:147], v7 offset:22528
    ds_read_b64_tr_b16 v[148:149], v7 offset:23552
    ds_read_b64_tr_b16 a[164:165], v8 offset:18432
    ds_read_b64_tr_b16 a[166:167], v8 offset:19456
    v_mov_b32 v188, v172
    s_waitcnt vmcnt(13) lgkmcnt(10)
    v_mfma_f32_32x32x16_bf16 v[66:81], v[134:137], a[40:43], v[66:81]
    s_mov_b32 s8, 49152
    buffer_load_dwordx4 a[96:99], v28, s[48:51], s8 offen sc1
    ds_read_b64_tr_b16 v[36:37], v6 offset:24576
    ds_read_b64_tr_b16 v[38:39], v6 offset:25600
    v_mov_b32 v189, v173
    s_waitcnt lgkmcnt(10)
    v_mfma_f32_32x32x16_bf16 v[82:97], v[138:141], a[40:43], v[82:97]
    ds_read_b64_tr_b16 v[130:131], v7 offset:24576
    ds_read_b64_tr_b16 v[132:133], v7 offset:25600
    ds_read_b64_tr_b16 a[168:169], v8 offset:20480
    ds_read_b64_tr_b16 a[170:171], v8 offset:21504
    v_mov_b32 v153, 0
    s_waitcnt vmcnt(13) lgkmcnt(10)
    v_mfma_f32_32x32x16_bf16 v[66:81], v[142:145], a[44:47], v[66:81]
    buffer_load_dwordx4 a[100:103], v28, s[48:51], s8 offen offset:2048 sc1
    ds_read_b64_tr_b16 v[134:135], v6 offset:26624
    ds_read_b64_tr_b16 v[136:137], v6 offset:27648
    v_permlane32_swap_b32 v172, v188
    s_waitcnt lgkmcnt(10)
    v_mfma_f32_32x32x16_bf16 v[82:97], v[146:149], a[44:47], v[82:97]
    ds_read_b64_tr_b16 v[138:139], v7 offset:26624
    ds_read_b64_tr_b16 v[140:141], v7 offset:27648
    ds_read_b64_tr_b16 a[172:173], v8 offset:22528
    ds_read_b64_tr_b16 a[174:175], v8 offset:23552
    s_waitcnt vmcnt(13) lgkmcnt(10)
    v_mfma_f32_32x32x16_bf16 v[66:81], v[36:39], a[48:51], v[66:81]
    s_mov_b32 s8, 53248
    buffer_load_dwordx4 a[104:107], v28, s[48:51], s8 offen sc1
    ds_read_b64_tr_b16 v[142:143], v6 offset:28672
    ds_read_b64_tr_b16 v[144:145], v6 offset:29696
    s_waitcnt lgkmcnt(10)
    v_mfma_f32_32x32x16_bf16 v[82:97], v[130:133], a[48:51], v[82:97]
    ds_read_b64_tr_b16 v[146:147], v7 offset:28672
    ds_read_b64_tr_b16 v[148:149], v7 offset:29696
    ds_read_b64_tr_b16 a[176:177], v8 offset:24576
    ds_read_b64_tr_b16 a[178:179], v8 offset:25600
    s_waitcnt vmcnt(13) lgkmcnt(10)
    v_mfma_f32_32x32x16_bf16 v[66:81], v[134:137], a[52:55], v[66:81]
    buffer_load_dwordx4 a[108:111], v28, s[48:51], s8 offen offset:2048 sc1
    ds_read_b64_tr_b16 v[36:37], v6 offset:30720
    ds_read_b64_tr_b16 v[38:39], v6 offset:31744
    v_permlane32_swap_b32 v173, v189
    s_waitcnt lgkmcnt(10)
    v_mfma_f32_32x32x16_bf16 v[82:97], v[138:141], a[52:55], v[82:97]
    ds_read_b64_tr_b16 v[130:131], v7 offset:30720
    ds_read_b64_tr_b16 v[132:133], v7 offset:31744
    ds_read_b64_tr_b16 a[180:181], v8 offset:26624
    ds_read_b64_tr_b16 a[182:183], v8 offset:27648
    v_add_f32 v172, v172, v188
    s_waitcnt vmcnt(13) lgkmcnt(10)
    v_mfma_f32_32x32x16_bf16 v[66:81], v[142:145], a[56:59], v[66:81]
    s_mov_b32 s8, 57344
    buffer_load_dwordx4 a[112:115], v28, s[48:51], s8 offen sc1
    ds_read_b64_tr_b16 v[134:135], v6 offset:32768
    ds_read_b64_tr_b16 v[136:137], v6 offset:33792
    v_add_f32 v173, v173, v189
    s_waitcnt lgkmcnt(10)
    v_mfma_f32_32x32x16_bf16 v[82:97], v[146:149], a[56:59], v[82:97]
    ds_read_b64_tr_b16 v[138:139], v7 offset:32768
    ds_read_b64_tr_b16 v[140:141], v7 offset:33792
    ds_read_b64_tr_b16 a[184:185], v8 offset:28672
    ds_read_b64_tr_b16 a[186:187], v8 offset:29696
    v_mul_f32 v188, 0x3b000000, v172
    s_waitcnt vmcnt(13) lgkmcnt(10)
    v_mfma_f32_32x32x16_bf16 v[66:81], v[36:39], a[60:63], v[66:81]
    buffer_load_dwordx4 a[116:119], v28, s[48:51], s8 offen offset:2048 sc1
    ds_read_b64_tr_b16 v[142:143], v6 offset:34816
    ds_read_b64_tr_b16 v[144:145], v6 offset:35840
    v_mul_f32 v189, 0x3b000000, v173
    v_add_f32 v189, 0x3727c5ac, v189
    s_waitcnt lgkmcnt(10)
    v_mfma_f32_32x32x16_bf16 v[82:97], v[130:133], a[60:63], v[82:97]
    ds_read_b64_tr_b16 v[146:147], v7 offset:34816
    ds_read_b64_tr_b16 v[148:149], v7 offset:35840
    ds_read_b64_tr_b16 a[188:189], v8 offset:30720
    ds_read_b64_tr_b16 a[190:191], v8 offset:31744
    v_fma_f32 v189, -v188, v188, v189
    s_waitcnt vmcnt(13) lgkmcnt(10)
    v_mfma_f32_32x32x16_bf16 v[66:81], v[134:137], a[64:67], v[66:81]
    s_mov_b32 s8, 61440
    buffer_load_dwordx4 a[120:123], v28, s[48:51], s8 offen sc1
    ds_read_b64_tr_b16 v[36:37], v6 offset:36864
    ds_read_b64_tr_b16 v[38:39], v6 offset:37888
    s_waitcnt lgkmcnt(10)
    v_mfma_f32_32x32x16_bf16 v[82:97], v[138:141], a[64:67], v[82:97]
    ds_read_b64_tr_b16 v[130:131], v7 offset:36864
    ds_read_b64_tr_b16 v[132:133], v7 offset:37888
    ds_read_b64_tr_b16 a[192:193], v8 offset:32768
    ds_read_b64_tr_b16 a[194:195], v8 offset:33792
    s_waitcnt vmcnt(13) lgkmcnt(10)
    v_mfma_f32_32x32x16_bf16 v[66:81], v[142:145], a[68:71], v[66:81]
    buffer_load_dwordx4 a[124:127], v28, s[48:51], s8 offen offset:2048 sc1
    ds_read_b64_tr_b16 v[134:135], v6 offset:38912
    ds_read_b64_tr_b16 v[136:137], v6 offset:39936
    v_rsq_f32 v12, v189
    s_waitcnt lgkmcnt(10)
    v_mfma_f32_32x32x16_bf16 v[82:97], v[146:149], a[68:71], v[82:97]
    ds_read_b64_tr_b16 v[138:139], v7 offset:38912
    ds_read_b64_tr_b16 v[140:141], v7 offset:39936
    ds_read_b64_tr_b16 a[196:197], v8 offset:34816
    ds_read_b64_tr_b16 a[198:199], v8 offset:35840
    v_mul_f32 v188, -0.5, v188
    s_waitcnt vmcnt(13) lgkmcnt(10)
    v_mfma_f32_32x32x16_bf16 v[66:81], v[36:39], a[72:75], v[66:81]
    ds_read_b64_tr_b16 v[142:143], v6 offset:40960
    ds_read_b64_tr_b16 v[144:145], v6 offset:41984
    v_mul_f32 v156, v189, v12
    v_mul_f32 v158, 0xc0135761, v12
    v_mul_f32 v189, v12, v12
    s_waitcnt lgkmcnt(10)
    v_mfma_f32_32x32x16_bf16 v[82:97], v[130:133], a[72:75], v[82:97]
    ds_read_b64_tr_b16 v[146:147], v7 offset:40960
    ds_read_b64_tr_b16 v[148:149], v7 offset:41984
    ds_read_b64_tr_b16 a[200:201], v8 offset:36864
    ds_read_b64_tr_b16 a[202:203], v8 offset:37888
    v_mul_f32 v189, v189, v12
    s_waitcnt vmcnt(12) lgkmcnt(10)
    v_mfma_f32_32x32x16_bf16 v[66:81], v[134:137], a[76:79], v[66:81]
    ds_read_b64_tr_b16 v[36:37], v6 offset:43008
    ds_read_b64_tr_b16 v[38:39], v6 offset:44032
    v_mul_f32 v154, 0xbdd2d3e8, v189
    v_cvt_pk_bf16_f32 v190, v188, v188
    v_and_b32 v190, 0xffff0000, v190
    s_waitcnt lgkmcnt(10)
    v_mfma_f32_32x32x16_bf16 v[82:97], v[138:141], a[76:79], v[82:97]
    ds_read_b64_tr_b16 v[130:131], v7 offset:43008
    ds_read_b64_tr_b16 v[132:133], v7 offset:44032
    ds_read_b64_tr_b16 a[204:205], v8 offset:38912
    ds_read_b64_tr_b16 a[206:207], v8 offset:39936
    v_sub_f32 v191, v188, v190
    s_waitcnt vmcnt(11) lgkmcnt(10)
    v_mfma_f32_32x32x16_bf16 v[66:81], v[142:145], a[80:83], v[66:81]
    ds_read_b64_tr_b16 v[134:135], v6 offset:45056
    ds_read_b64_tr_b16 v[136:137], v6 offset:46080
    v_cvt_pk_bf16_f32 v150, v190, v191
    v_mov_b32 v151, v150
    v_mul_f32 v188, 0.5, v156
    s_waitcnt lgkmcnt(10)
    v_mfma_f32_32x32x16_bf16 v[82:97], v[146:149], a[80:83], v[82:97]
    ds_read_b64_tr_b16 v[138:139], v7 offset:45056
    ds_read_b64_tr_b16 v[140:141], v7 offset:46080
    ds_read_b64_tr_b16 a[208:209], v8 offset:40960
    ds_read_b64_tr_b16 a[210:211], v8 offset:41984
    v_cvt_pk_bf16_f32 v190, v188, v188
    s_waitcnt vmcnt(10) lgkmcnt(10)
    v_mfma_f32_32x32x16_bf16 v[66:81], v[36:39], a[84:87], v[66:81]
    ds_read_b64_tr_b16 v[142:143], v6 offset:47104
    ds_read_b64_tr_b16 v[144:145], v6 offset:48128
    v_and_b32 v190, 0xffff0000, v190
    v_sub_f32 v191, v188, v190
    v_cvt_pk_bf16_f32 v152, v190, v191
    s_waitcnt lgkmcnt(10)
    v_mfma_f32_32x32x16_bf16 v[82:97], v[130:133], a[84:87], v[82:97]
    ds_read_b64_tr_b16 v[146:147], v7 offset:47104
    ds_read_b64_tr_b16 v[148:149], v7 offset:48128
    ds_read_b64_tr_b16 a[212:213], v8 offset:43008
    ds_read_b64_tr_b16 a[214:215], v8 offset:44032
    s_waitcnt vmcnt(9) lgkmcnt(10)
    v_mfma_f32_32x32x16_bf16 v[66:81], v[134:137], a[88:91], v[66:81]
    ds_read_b64_tr_b16 v[36:37], v6 offset:49152
    ds_read_b64_tr_b16 v[38:39], v6 offset:50176
    s_waitcnt lgkmcnt(10)
    v_mfma_f32_32x32x16_bf16 v[82:97], v[138:141], a[88:91], v[82:97]
    ds_read_b64_tr_b16 v[130:131], v7 offset:49152
    ds_read_b64_tr_b16 v[132:133], v7 offset:50176
    ds_read_b64_tr_b16 a[216:217], v8 offset:45056
    ds_read_b64_tr_b16 a[218:219], v8 offset:46080
    s_waitcnt vmcnt(8) lgkmcnt(10)
    v_mfma_f32_32x32x16_bf16 v[66:81], v[142:145], a[92:95], v[66:81]
    ds_read_b64_tr_b16 v[134:135], v6 offset:51200
    ds_read_b64_tr_b16 v[136:137], v6 offset:52224
    s_waitcnt lgkmcnt(10)
    v_mfma_f32_32x32x16_bf16 v[82:97], v[146:149], a[92:95], v[82:97]
    ds_read_b64_tr_b16 v[138:139], v7 offset:51200
    ds_read_b64_tr_b16 v[140:141], v7 offset:52224
    ds_read_b64_tr_b16 a[220:221], v8 offset:47104
    ds_read_b64_tr_b16 a[222:223], v8 offset:48128
    s_waitcnt vmcnt(7) lgkmcnt(10)
    v_mfma_f32_32x32x16_bf16 v[66:81], v[36:39], a[96:99], v[66:81]
    ds_read_b64_tr_b16 v[142:143], v6 offset:53248
    ds_read_b64_tr_b16 v[144:145], v6 offset:54272
    s_waitcnt lgkmcnt(10)
    v_mfma_f32_32x32x16_bf16 v[82:97], v[130:133], a[96:99], v[82:97]
    ds_read_b64_tr_b16 v[146:147], v7 offset:53248
    ds_read_b64_tr_b16 v[148:149], v7 offset:54272
    ds_read_b64_tr_b16 a[224:225], v8 offset:49152
    ds_read_b64_tr_b16 a[226:227], v8 offset:50176
    s_waitcnt vmcnt(6) lgkmcnt(10)
    v_mfma_f32_32x32x16_bf16 v[66:81], v[134:137], a[100:103], v[66:81]
    ds_read_b64_tr_b16 v[36:37], v6 offset:55296
    ds_read_b64_tr_b16 v[38:39], v6 offset:56320
    s_waitcnt lgkmcnt(10)
    v_mfma_f32_32x32x16_bf16 v[82:97], v[138:141], a[100:103], v[82:97]
    ds_read_b64_tr_b16 v[130:131], v7 offset:55296
    ds_read_b64_tr_b16 v[132:133], v7 offset:56320
    ds_read_b64_tr_b16 a[228:229], v8 offset:51200
    ds_read_b64_tr_b16 a[230:231], v8 offset:52224
    s_waitcnt vmcnt(5) lgkmcnt(10)
    v_mfma_f32_32x32x16_bf16 v[66:81], v[142:145], a[104:107], v[66:81]
    ds_read_b64_tr_b16 v[134:135], v6 offset:57344
    ds_read_b64_tr_b16 v[136:137], v6 offset:58368
    s_waitcnt lgkmcnt(10)
    v_mfma_f32_32x32x16_bf16 v[82:97], v[146:149], a[104:107], v[82:97]
    ds_read_b64_tr_b16 v[138:139], v7 offset:57344
    ds_read_b64_tr_b16 v[140:141], v7 offset:58368
    ds_read_b64_tr_b16 a[232:233], v8 offset:53248
    ds_read_b64_tr_b16 a[234:235], v8 offset:54272
    s_waitcnt vmcnt(4) lgkmcnt(10)
    v_mfma_f32_32x32x16_bf16 v[66:81], v[36:39], a[108:111], v[66:81]
    ds_read_b64_tr_b16 v[142:143], v6 offset:59392
    ds_read_b64_tr_b16 v[144:145], v6 offset:60416
    s_waitcnt lgkmcnt(10)
    v_mfma_f32_32x32x16_bf16 v[82:97], v[130:133], a[108:111], v[82:97]
    ds_read_b64_tr_b16 v[146:147], v7 offset:59392
    ds_read_b64_tr_b16 v[148:149], v7 offset:60416
    ds_read_b64_tr_b16 a[236:237], v8 offset:55296
    ds_read_b64_tr_b16 a[238:239], v8 offset:56320
    s_waitcnt vmcnt(3) lgkmcnt(10)
    v_mfma_f32_32x32x16_bf16 v[66:81], v[134:137], a[112:115], v[66:81]
    ds_read_b64_tr_b16 v[36:37], v6 offset:61440
    ds_read_b64_tr_b16 v[38:39], v6 offset:62464
    s_waitcnt lgkmcnt(10)
    v_mfma_f32_32x32x16_bf16 v[82:97], v[138:141], a[112:115], v[82:97]
    ds_read_b64_tr_b16 v[130:131], v7 offset:61440
    ds_read_b64_tr_b16 v[132:133], v7 offset:62464
    ds_read_b64_tr_b16 a[240:241], v8 offset:57344
    ds_read_b64_tr_b16 a[242:243], v8 offset:58368
    s_waitcnt vmcnt(2) lgkmcnt(10)
    v_mfma_f32_32x32x16_bf16 v[66:81], v[142:145], a[116:119], v[66:81]
    ds_read_b64_tr_b16 v[134:135], v6 offset:63488
    ds_read_b64_tr_b16 v[136:137], v6 offset:64512
    s_waitcnt lgkmcnt(10)
    v_mfma_f32_32x32x16_bf16 v[82:97], v[146:149], a[116:119], v[82:97]
    ds_read_b64_tr_b16 v[138:139], v7 offset:63488
    ds_read_b64_tr_b16 v[140:141], v7 offset:64512
    ds_read_b64_tr_b16 a[244:245], v8 offset:59392
    ds_read_b64_tr_b16 a[246:247], v8 offset:60416
    s_waitcnt vmcnt(1) lgkmcnt(10)
    v_mfma_f32_32x32x16_bf16 v[66:81], v[36:39], a[120:123], v[66:81]
    s_waitcnt lgkmcnt(8)
    v_mfma_f32_32x32x16_bf16 v[82:97], v[130:133], a[120:123], v[82:97]
    ds_read_b64_tr_b16 a[248:249], v8 offset:61440
    ds_read_b64_tr_b16 a[250:251], v8 offset:62464
    s_waitcnt vmcnt(0) lgkmcnt(6)
    v_mfma_f32_32x32x16_bf16 v[66:81], v[134:137], a[124:127], v[66:81]
    s_waitcnt lgkmcnt(4)
    v_mfma_f32_32x32x16_bf16 v[82:97], v[138:141], a[124:127], v[82:97]
    ds_read_b64_tr_b16 a[252:253], v8 offset:63488
    ds_read_b64_tr_b16 a[254:255], v8 offset:64512
    v_mfma_f32_32x32x16_bf16 v[66:81], v[48:51], v[150:153], v[66:81]
    v_mfma_f32_32x32x16_bf16 v[82:97], v[54:57], v[150:153], v[82:97]
    s_barrier
    s_cmp_eq_u32 s56, 0
    s_cselect_b64 exec, 1, 0
    buffer_store_dwordx2 v[32:33], v30, s[48:51], 0 offen offset:640 sc1
    s_mov_b64 exec, -1
    s_waitcnt lgkmcnt(0)
    v_mfma_f32_32x32x16_bf16 v[98:113], a[128:131], a[0:3], 0
    ds_read_b64_tr_b16 a[128:129], v9 offset:0
    ds_read_b64_tr_b16 a[130:131], v9 offset:1024
    s_add_u32 m0, s20, 0
    s_add_u32 s8, s23, 0
    v_mul_f32 v188, v66, v66
    v_mul_f32 v189, v67, v67
    v_mfma_f32_32x32x16_bf16 v[98:113], a[132:135], a[4:7], v[98:113]
    buffer_load_dwordx4 v22, s[44:47], s8 offen lds
    ds_read_b64_tr_b16 a[132:133], v9 offset:2048
    ds_read_b64_tr_b16 a[134:135], v9 offset:3072
    v_mul_f32 v190, v68, v68
    v_mul_f32 v191, v69, v69
    v_mul_f32 v192, v70, v70
    v_mfma_f32_32x32x16_bf16 v[98:113], a[136:139], a[8:11], v[98:113]
    buffer_load_dwordx4 v23, s[44:47], s8 offen offset:1024 lds
    ds_read_b64_tr_b16 a[136:137], v9 offset:4096
    ds_read_b64_tr_b16 a[138:139], v9 offset:5120
    v_mul_f32 v193, v71, v71
    v_mul_f32 v194, v72, v72
    v_mul_f32 v195, v73, v73
    v_mfma_f32_32x32x16_bf16 v[98:113], a[140:143], a[12:15], v[98:113]
    buffer_load_dwordx4 v24, s[44:47], s8 offen offset:2048 lds
    ds_read_b64_tr_b16 a[140:141], v9 offset:6144
    ds_read_b64_tr_b16 a[142:143], v9 offset:7168
    v_fma_f32 v188, v188, v154, v158
    v_fma_f32 v189, v189, v154, v158
    v_fma_f32 v190, v190, v154, v158
    v_mfma_f32_32x32x16_bf16 v[98:113], a[144:147], a[16:19], v[98:113]
    ds_read_b64_tr_b16 a[144:145], v9 offset:8192
    ds_read_b64_tr_b16 a[146:147], v9 offset:9216
    v_fma_f32 v191, v191, v154, v158
    v_fma_f32 v192, v192, v154, v158
    v_fma_f32 v193, v193, v154, v158
    v_fma_f32 v194, v194, v154, v158
    v_mfma_f32_32x32x16_bf16 v[98:113], a[148:151], a[20:23], v[98:113]
    buffer_load_dwordx4 v25, s[44:47], s8 offen offset:3072 lds
    ds_read_b64_tr_b16 a[148:149], v9 offset:10240
    ds_read_b64_tr_b16 a[150:151], v9 offset:11264
    s_add_u32 m0, s20, 4096
    s_add_u32 s8, s23, 32768
    v_fma_f32 v195, v195, v154, v158
    v_mfma_f32_32x32x16_bf16 v[98:113], a[152:155], a[24:27], v[98:113]
    buffer_load_dwordx4 v22, s[44:47], s8 offen lds
    ds_read_b64_tr_b16 a[152:153], v9 offset:12288
    ds_read_b64_tr_b16 a[154:155], v9 offset:13312
    v_mul_f32 v188, v66, v188
    v_mul_f32 v189, v67, v189
    v_mul_f32 v190, v68, v190
    v_mfma_f32_32x32x16_bf16 v[98:113], a[156:159], a[28:31], v[98:113]
    ds_read_b64_tr_b16 a[156:157], v9 offset:14336
    ds_read_b64_tr_b16 a[158:159], v9 offset:15360
    v_mul_f32 v191, v69, v191
    v_mul_f32 v192, v70, v192
    v_mul_f32 v193, v71, v193
    v_mul_f32 v194, v72, v194
    v_mfma_f32_32x32x16_bf16 v[98:113], a[160:163], a[32:35], v[98:113]
    buffer_load_dwordx4 v23, s[44:47], s8 offen offset:1024 lds
    ds_read_b64_tr_b16 a[160:161], v9 offset:16384
    ds_read_b64_tr_b16 a[162:163], v9 offset:17408
    s_add_u32 m0, s21, 0
    s_add_u32 s8, s23, 49152
    v_mul_f32 v195, v73, v195
    v_mfma_f32_32x32x16_bf16 v[98:113], a[164:167], a[36:39], v[98:113]
    buffer_load_dwordx4 v22, s[44:47], s8 offen lds
    ds_read_b64_tr_b16 a[164:165], v9 offset:18432
    ds_read_b64_tr_b16 a[166:167], v9 offset:19456
    v_exp_f32 v188, v188
    v_mfma_f32_32x32x16_bf16 v[98:113], a[168:171], a[40:43], v[98:113]
    buffer_load_dwordx4 v23, s[44:47], s8 offen offset:1024 lds
    ds_read_b64_tr_b16 a[168:169], v9 offset:20480
    ds_read_b64_tr_b16 a[170:171], v9 offset:21504
    v_exp_f32 v189, v189
    v_mfma_f32_32x32x16_bf16 v[98:113], a[172:175], a[44:47], v[98:113]
    ds_read_b64_tr_b16 a[172:173], v9 offset:22528
    ds_read_b64_tr_b16 a[174:175], v9 offset:23552
    v_exp_f32 v190, v190
    v_exp_f32 v191, v191
    v_mfma_f32_32x32x16_bf16 v[98:113], a[176:179], a[48:51], v[98:113]
    buffer_load_dwordx4 v24, s[44:47], s8 offen offset:2048 lds
    ds_read_b64_tr_b16 a[176:177], v9 offset:24576
    ds_read_b64_tr_b16 a[178:179], v9 offset:25600
    v_exp_f32 v192, v192
    v_mfma_f32_32x32x16_bf16 v[98:113], a[180:183], a[52:55], v[98:113]
    buffer_load_dwordx4 v25, s[44:47], s8 offen offset:3072 lds
    ds_read_b64_tr_b16 a[180:181], v9 offset:26624
    ds_read_b64_tr_b16 a[182:183], v9 offset:27648
    v_exp_f32 v193, v193
    v_mfma_f32_32x32x16_bf16 v[98:113], a[184:187], a[56:59], v[98:113]
    ds_read_b64_tr_b16 a[184:185], v9 offset:28672
    ds_read_b64_tr_b16 a[186:187], v9 offset:29696
    s_add_u32 m0, s21, 4096
    s_add_u32 s8, s23, 81920
    v_exp_f32 v194, v194
    v_mfma_f32_32x32x16_bf16 v[98:113], a[188:191], a[60:63], v[98:113]
    buffer_load_dwordx4 v22, s[44:47], s8 offen lds
    ds_read_b64_tr_b16 a[188:189], v9 offset:30720
    ds_read_b64_tr_b16 a[190:191], v9 offset:31744
    v_exp_f32 v195, v195
    v_fma_f32 v188, v188, v156, v156
    v_mfma_f32_32x32x16_bf16 v[98:113], a[192:195], a[64:67], v[98:113]
    buffer_load_dwordx4 v23, s[44:47], s8 offen offset:1024 lds
    ds_read_b64_tr_b16 a[192:193], v9 offset:32768
    ds_read_b64_tr_b16 a[194:195], v9 offset:33792
    v_fma_f32 v189, v189, v156, v156
    v_fma_f32 v190, v190, v156, v156
    v_fma_f32 v191, v191, v156, v156
    v_mfma_f32_32x32x16_bf16 v[98:113], a[196:199], a[68:71], v[98:113]
    buffer_load_dwordx4 v24, s[44:47], s8 offen offset:2048 lds
    ds_read_b64_tr_b16 a[196:197], v9 offset:34816
    ds_read_b64_tr_b16 a[198:199], v9 offset:35840
    v_fma_f32 v192, v192, v156, v156
    v_fma_f32 v193, v193, v156, v156
    v_fma_f32 v194, v194, v156, v156
    v_mfma_f32_32x32x16_bf16 v[98:113], a[200:203], a[72:75], v[98:113]
    ds_read_b64_tr_b16 a[200:201], v9 offset:36864
    ds_read_b64_tr_b16 a[202:203], v9 offset:37888
    v_fma_f32 v195, v195, v156, v156
    v_rcp_f32 v188, v188
    v_mfma_f32_32x32x16_bf16 v[98:113], a[204:207], a[76:79], v[98:113]
    buffer_load_dwordx4 v25, s[44:47], s8 offen offset:3072 lds
    ds_read_b64_tr_b16 a[204:205], v9 offset:38912
    ds_read_b64_tr_b16 a[206:207], v9 offset:39936
    s_add_u32 m0, s21, 8192
    s_add_u32 s8, s23, 114688
    v_mfma_f32_32x32x16_bf16 v[98:113], a[208:211], a[80:83], v[98:113]
    buffer_load_dwordx4 v22, s[44:47], s8 offen lds
    ds_read_b64_tr_b16 a[208:209], v9 offset:40960
    ds_read_b64_tr_b16 a[210:211], v9 offset:41984
    v_rcp_f32 v189, v189
    v_mfma_f32_32x32x16_bf16 v[98:113], a[212:215], a[84:87], v[98:113]
    ds_read_b64_tr_b16 a[212:213], v9 offset:43008
    ds_read_b64_tr_b16 a[214:215], v9 offset:44032
    v_rcp_f32 v190, v190
    v_rcp_f32 v191, v191
    v_mfma_f32_32x32x16_bf16 v[98:113], a[216:219], a[88:91], v[98:113]
    buffer_load_dwordx4 v23, s[44:47], s8 offen offset:1024 lds
    ds_read_b64_tr_b16 a[216:217], v9 offset:45056
    ds_read_b64_tr_b16 a[218:219], v9 offset:46080
    v_rcp_f32 v192, v192
    v_mfma_f32_32x32x16_bf16 v[98:113], a[220:223], a[92:95], v[98:113]
    buffer_load_dwordx4 v24, s[44:47], s8 offen offset:2048 lds
    ds_read_b64_tr_b16 a[220:221], v9 offset:47104
    ds_read_b64_tr_b16 a[222:223], v9 offset:48128
    v_rcp_f32 v193, v193
    v_mfma_f32_32x32x16_bf16 v[98:113], a[224:227], a[96:99], v[98:113]
    buffer_load_dwordx4 v25, s[44:47], s8 offen offset:3072 lds
    ds_read_b64_tr_b16 a[224:225], v9 offset:49152
    ds_read_b64_tr_b16 a[226:227], v9 offset:50176
    v_rcp_f32 v194, v194
    v_mfma_f32_32x32x16_bf16 v[98:113], a[228:231], a[100:103], v[98:113]
    ds_read_b64_tr_b16 a[228:229], v9 offset:51200
    ds_read_b64_tr_b16 a[230:231], v9 offset:52224
    s_add_u32 m0, s21, 12288
    s_add_u32 s8, s23, 147456
    v_rcp_f32 v195, v195
    v_mfma_f32_32x32x16_bf16 v[98:113], a[232:235], a[104:107], v[98:113]
    buffer_load_dwordx4 v22, s[44:47], s8 offen lds
    ds_read_b64_tr_b16 a[232:233], v9 offset:53248
    ds_read_b64_tr_b16 a[234:235], v9 offset:54272
    v_mul_f32 v66, v66, v188
    v_mul_f32 v67, v67, v189
    v_mul_f32 v68, v68, v190
    v_mfma_f32_32x32x16_bf16 v[98:113], a[236:239], a[108:111], v[98:113]
    buffer_load_dwordx4 v23, s[44:47], s8 offen offset:1024 lds
    ds_read_b64_tr_b16 a[236:237], v9 offset:55296
    ds_read_b64_tr_b16 a[238:239], v9 offset:56320
    v_mul_f32 v69, v69, v191
    v_mul_f32 v70, v70, v192
    v_mul_f32 v71, v71, v193
    v_mfma_f32_32x32x16_bf16 v[98:113], a[240:243], a[112:115], v[98:113]
    ds_read_b64_tr_b16 a[240:241], v9 offset:57344
    ds_read_b64_tr_b16 a[242:243], v9 offset:58368
    v_mul_f32 v72, v72, v194
    v_mul_f32 v73, v73, v195
    v_cvt_pk_bf16_f32 v66, v66, v67
    v_cvt_pk_bf16_f32 v67, v68, v69
    v_mfma_f32_32x32x16_bf16 v[98:113], a[244:247], a[116:119], v[98:113]
    buffer_load_dwordx4 v24, s[44:47], s8 offen offset:2048 lds
    ds_read_b64_tr_b16 a[244:245], v9 offset:59392
    ds_read_b64_tr_b16 a[246:247], v9 offset:60416
    v_cvt_pk_bf16_f32 v68, v70, v71
    v_cvt_pk_bf16_f32 v69, v72, v73
    buffer_store_dwordx4 v[66:69], v34, s[48:51], 0 offen sc1
    v_mfma_f32_32x32x16_bf16 v[98:113], a[248:251], a[120:123], v[98:113]
    buffer_load_dwordx4 v25, s[44:47], s8 offen offset:3072 lds
    ds_read_b64_tr_b16 a[248:249], v9 offset:61440
    ds_read_b64_tr_b16 a[250:251], v9 offset:62464
    v_mul_f32 v196, v74, v74
    v_mul_f32 v197, v75, v75
    v_mul_f32 v198, v76, v76
    v_mfma_f32_32x32x16_bf16 v[98:113], a[252:255], a[124:127], v[98:113]
    ds_read_b64_tr_b16 a[252:253], v9 offset:63488
    ds_read_b64_tr_b16 a[254:255], v9 offset:64512
    v_mul_f32 v199, v77, v77
    v_mul_f32 v200, v78, v78
    v_mul_f32 v201, v79, v79
    v_mul_f32 v202, v80, v80
    v_mfma_f32_32x32x16_bf16 v[98:113], v[58:61], v[150:153], v[98:113]
    v_mul_f32 v203, v81, v81
    v_fma_f32 v196, v196, v154, v158
    v_fma_f32 v197, v197, v154, v158
    v_fma_f32 v198, v198, v154, v158
    v_fma_f32 v199, v199, v154, v158
    v_fma_f32 v200, v200, v154, v158
    s_waitcnt lgkmcnt(0)
    s_barrier
    v_mfma_f32_32x32x16_bf16 v[114:129], a[128:131], a[0:3], 0
    s_add_u32 m0, s22, 0
    s_add_u32 s8, s23, 180224
    v_fma_f32 v201, v201, v154, v158
    v_fma_f32 v202, v202, v154, v158
    v_fma_f32 v203, v203, v154, v158
    v_mul_f32 v196, v74, v196
    v_mul_f32 v197, v75, v197
    v_mul_f32 v198, v76, v198
    v_mfma_f32_32x32x16_bf16 v[114:129], a[132:135], a[4:7], v[114:129]
    buffer_load_dwordx4 v22, s[44:47], s8 offen lds
    v_mul_f32 v199, v77, v199
    v_mul_f32 v200, v78, v200
    v_mul_f32 v201, v79, v201
    v_mul_f32 v202, v80, v202
    v_mul_f32 v203, v81, v203
    v_exp_f32 v196, v196
    v_mfma_f32_32x32x16_bf16 v[114:129], a[136:139], a[8:11], v[114:129]
    v_exp_f32 v197, v197
    v_exp_f32 v198, v198
    v_exp_f32 v199, v199
    v_exp_f32 v200, v200
    v_mfma_f32_32x32x16_bf16 v[114:129], a[140:143], a[12:15], v[114:129]
    buffer_load_dwordx4 v23, s[44:47], s8 offen offset:1024 lds
    v_exp_f32 v201, v201
    v_exp_f32 v202, v202
    v_exp_f32 v203, v203
    v_fma_f32 v196, v196, v156, v156
    v_mfma_f32_32x32x16_bf16 v[114:129], a[144:147], a[16:19], v[114:129]
    v_fma_f32 v197, v197, v156, v156
    v_fma_f32 v198, v198, v156, v156
    v_fma_f32 v199, v199, v156, v156
    v_fma_f32 v200, v200, v156, v156
    v_fma_f32 v201, v201, v156, v156
    v_fma_f32 v202, v202, v156, v156
    v_fma_f32 v203, v203, v156, v156
    v_mfma_f32_32x32x16_bf16 v[114:129], a[148:151], a[20:23], v[114:129]
    buffer_load_dwordx4 v24, s[44:47], s8 offen offset:2048 lds
    v_rcp_f32 v196, v196
    v_rcp_f32 v197, v197
    v_rcp_f32 v198, v198
    v_mfma_f32_32x32x16_bf16 v[114:129], a[152:155], a[24:27], v[114:129]
    v_rcp_f32 v199, v199
    v_rcp_f32 v200, v200
    v_rcp_f32 v201, v201
    v_rcp_f32 v202, v202
    v_mfma_f32_32x32x16_bf16 v[114:129], a[156:159], a[28:31], v[114:129]
    buffer_load_dwordx4 v25, s[44:47], s8 offen offset:3072 lds
    v_rcp_f32 v203, v203
    v_mul_f32 v74, v74, v196
    v_mul_f32 v75, v75, v197
    v_mul_f32 v76, v76, v198
    v_mul_f32 v77, v77, v199
    v_mul_f32 v78, v78, v200
    v_mfma_f32_32x32x16_bf16 v[114:129], a[160:163], a[32:35], v[114:129]
    s_add_u32 m0, s22, 4096
    s_add_u32 s8, s23, 212992
    v_mul_f32 v79, v79, v201
    v_mul_f32 v80, v80, v202
    v_mul_f32 v81, v81, v203
    v_cvt_pk_bf16_f32 v74, v74, v75
    v_cvt_pk_bf16_f32 v75, v76, v77
    v_cvt_pk_bf16_f32 v76, v78, v79
    v_mfma_f32_32x32x16_bf16 v[114:129], a[164:167], a[36:39], v[114:129]
    buffer_load_dwordx4 v22, s[44:47], s8 offen lds
    v_cvt_pk_bf16_f32 v77, v80, v81
    buffer_store_dwordx4 v[74:77], v34, s[48:51], 0 offen offset:2048 sc1
    v_mul_f32 v188, v82, v82
    v_mul_f32 v189, v83, v83
    v_mul_f32 v190, v84, v84
    v_mul_f32 v191, v85, v85
    v_mul_f32 v192, v86, v86
    v_mfma_f32_32x32x16_bf16 v[114:129], a[168:171], a[40:43], v[114:129]
    v_mul_f32 v193, v87, v87
    v_mul_f32 v194, v88, v88
    v_mul_f32 v195, v89, v89
    v_fma_f32 v188, v188, v154, v158
    v_fma_f32 v189, v189, v154, v158
    v_fma_f32 v190, v190, v154, v158
    v_fma_f32 v191, v191, v154, v158
    v_fma_f32 v192, v192, v154, v158
    v_mfma_f32_32x32x16_bf16 v[114:129], a[172:175], a[44:47], v[114:129]
    buffer_load_dwordx4 v23, s[44:47], s8 offen offset:1024 lds
    v_fma_f32 v193, v193, v154, v158
    v_fma_f32 v194, v194, v154, v158
    v_fma_f32 v195, v195, v154, v158
    v_mul_f32 v188, v82, v188
    v_mul_f32 v189, v83, v189
    v_mul_f32 v190, v84, v190
    v_mul_f32 v191, v85, v191
    v_mfma_f32_32x32x16_bf16 v[114:129], a[176:179], a[48:51], v[114:129]
    v_mul_f32 v192, v86, v192
    v_mul_f32 v193, v87, v193
    v_mul_f32 v194, v88, v194
    v_mul_f32 v195, v89, v195
    v_exp_f32 v188, v188
    v_exp_f32 v189, v189
    v_mfma_f32_32x32x16_bf16 v[114:129], a[180:183], a[52:55], v[114:129]
    buffer_load_dwordx4 v24, s[44:47], s8 offen offset:2048 lds
    v_exp_f32 v190, v190
    v_exp_f32 v191, v191
    v_exp_f32 v192, v192
    v_mfma_f32_32x32x16_bf16 v[114:129], a[184:187], a[56:59], v[114:129]
    v_exp_f32 v193, v193
    v_exp_f32 v194, v194
    v_exp_f32 v195, v195
    v_fma_f32 v188, v188, v156, v156
    v_fma_f32 v189, v189, v156, v156
    v_mfma_f32_32x32x16_bf16 v[114:129], a[188:191], a[60:63], v[114:129]
    buffer_load_dwordx4 v25, s[44:47], s8 offen offset:3072 lds
    v_fma_f32 v190, v190, v156, v156
    v_fma_f32 v191, v191, v156, v156
    v_fma_f32 v192, v192, v156, v156
    v_fma_f32 v193, v193, v156, v156
    v_fma_f32 v194, v194, v156, v156
    v_fma_f32 v195, v195, v156, v156
    v_mfma_f32_32x32x16_bf16 v[114:129], a[192:195], a[64:67], v[114:129]
    s_add_u32 m0, s22, 8192
    s_add_u32 s8, s23, 245760
    v_rcp_f32 v188, v188
    v_rcp_f32 v189, v189
    v_rcp_f32 v190, v190
    v_mfma_f32_32x32x16_bf16 v[114:129], a[196:199], a[68:71], v[114:129]
    buffer_load_dwordx4 v22, s[44:47], s8 offen lds
    v_rcp_f32 v191, v191
    v_rcp_f32 v192, v192
    v_rcp_f32 v193, v193
    v_mfma_f32_32x32x16_bf16 v[114:129], a[200:203], a[72:75], v[114:129]
    v_rcp_f32 v194, v194
    v_rcp_f32 v195, v195
    v_mul_f32 v82, v82, v188
    v_mul_f32 v83, v83, v189
    v_mul_f32 v84, v84, v190
    v_mul_f32 v85, v85, v191
    v_mfma_f32_32x32x16_bf16 v[114:129], a[204:207], a[76:79], v[114:129]
    buffer_load_dwordx4 v23, s[44:47], s8 offen offset:1024 lds
    v_mul_f32 v86, v86, v192
    v_mul_f32 v87, v87, v193
    v_mul_f32 v88, v88, v194
    v_mul_f32 v89, v89, v195
    v_cvt_pk_bf16_f32 v82, v82, v83
    v_cvt_pk_bf16_f32 v83, v84, v85
    v_cvt_pk_bf16_f32 v84, v86, v87
    v_mfma_f32_32x32x16_bf16 v[114:129], a[208:211], a[80:83], v[114:129]
    v_cvt_pk_bf16_f32 v85, v88, v89
    buffer_store_dwordx4 v[82:85], v34, s[48:51], s10 offen sc1
    v_mul_f32 v196, v90, v90
    v_mul_f32 v197, v91, v91
    v_mul_f32 v198, v92, v92
    v_mul_f32 v199, v93, v93
    v_mul_f32 v200, v94, v94
    v_mul_f32 v201, v95, v95
    v_mfma_f32_32x32x16_bf16 v[114:129], a[212:215], a[84:87], v[114:129]
    buffer_load_dwordx4 v24, s[44:47], s8 offen offset:2048 lds
    v_mul_f32 v202, v96, v96
    v_mul_f32 v203, v97, v97
    v_fma_f32 v196, v196, v154, v158
    v_fma_f32 v197, v197, v154, v158
    v_fma_f32 v198, v198, v154, v158
    v_fma_f32 v199, v199, v154, v158
    v_fma_f32 v200, v200, v154, v158
    v_mfma_f32_32x32x16_bf16 v[114:129], a[216:219], a[88:91], v[114:129]
    v_fma_f32 v201, v201, v154, v158
    v_fma_f32 v202, v202, v154, v158
    v_fma_f32 v203, v203, v154, v158
    v_mul_f32 v196, v90, v196
    v_mul_f32 v197, v91, v197
    v_mul_f32 v198, v92, v198
    v_mul_f32 v199, v93, v199
    v_mul_f32 v200, v94, v200
    v_mfma_f32_32x32x16_bf16 v[114:129], a[220:223], a[92:95], v[114:129]
    buffer_load_dwordx4 v25, s[44:47], s8 offen offset:3072 lds
    v_mul_f32 v201, v95, v201
    v_mul_f32 v202, v96, v202
    v_mul_f32 v203, v97, v203
    v_exp_f32 v196, v196
    v_exp_f32 v197, v197
    v_mfma_f32_32x32x16_bf16 v[114:129], a[224:227], a[96:99], v[114:129]
    s_add_u32 m0, s22, 12288
    s_add_u32 s8, s23, 278528
    v_exp_f32 v198, v198
    v_exp_f32 v199, v199
    v_exp_f32 v200, v200
    v_mfma_f32_32x32x16_bf16 v[114:129], a[228:231], a[100:103], v[114:129]
    buffer_load_dwordx4 v22, s[44:47], s8 offen lds
    v_exp_f32 v201, v201
    v_exp_f32 v202, v202
    v_exp_f32 v203, v203
    v_fma_f32 v196, v196, v156, v156
    v_mfma_f32_32x32x16_bf16 v[114:129], a[232:235], a[104:107], v[114:129]
    v_fma_f32 v197, v197, v156, v156
    v_fma_f32 v198, v198, v156, v156
    v_fma_f32 v199, v199, v156, v156
    v_fma_f32 v200, v200, v156, v156
    v_fma_f32 v201, v201, v156, v156
    v_fma_f32 v202, v202, v156, v156
    v_fma_f32 v203, v203, v156, v156
    v_mfma_f32_32x32x16_bf16 v[114:129], a[236:239], a[108:111], v[114:129]
    buffer_load_dwordx4 v23, s[44:47], s8 offen offset:1024 lds
    v_rcp_f32 v196, v196
    v_rcp_f32 v197, v197
    v_rcp_f32 v198, v198
    v_mfma_f32_32x32x16_bf16 v[114:129], a[240:243], a[112:115], v[114:129]
    v_rcp_f32 v199, v199
    v_rcp_f32 v200, v200
    v_rcp_f32 v201, v201
    v_rcp_f32 v202, v202
    v_mfma_f32_32x32x16_bf16 v[114:129], a[244:247], a[116:119], v[114:129]
    buffer_load_dwordx4 v24, s[44:47], s8 offen offset:2048 lds
    v_rcp_f32 v203, v203
    v_mul_f32 v90, v90, v196
    v_mul_f32 v91, v91, v197
    v_mul_f32 v92, v92, v198
    v_mul_f32 v93, v93, v199
    v_mul_f32 v94, v94, v200
    v_mfma_f32_32x32x16_bf16 v[114:129], a[248:251], a[120:123], v[114:129]
    v_mul_f32 v95, v95, v201
    v_mul_f32 v96, v96, v202
    v_mul_f32 v97, v97, v203
    v_cvt_pk_bf16_f32 v90, v90, v91
    v_cvt_pk_bf16_f32 v91, v92, v93
    v_cvt_pk_bf16_f32 v92, v94, v95
    v_cvt_pk_bf16_f32 v93, v96, v97
    buffer_store_dwordx4 v[90:93], v34, s[48:51], s10 offen offset:2048 sc1
    v_mfma_f32_32x32x16_bf16 v[114:129], a[252:255], a[124:127], v[114:129]
    buffer_load_dwordx4 v25, s[44:47], s8 offen offset:3072 lds
    v_mfma_f32_32x32x16_bf16 v[114:129], v[62:65], v[150:153], v[114:129]
    v_pk_mul_f32 v[188:189], v[98:99], v[98:99]
    v_pk_mul_f32 v[190:191], v[100:101], v[100:101]
    v_pk_mul_f32 v[192:193], v[102:103], v[102:103]
    v_pk_mul_f32 v[194:195], v[104:105], v[104:105]
    v_pk_fma_f32 v[188:189], v[188:189], v[154:155], v[158:159] op_sel_hi:[1,0,0]
    v_pk_fma_f32 v[190:191], v[190:191], v[154:155], v[158:159] op_sel_hi:[1,0,0]
    v_pk_fma_f32 v[192:193], v[192:193], v[154:155], v[158:159] op_sel_hi:[1,0,0]
    v_pk_fma_f32 v[194:195], v[194:195], v[154:155], v[158:159] op_sel_hi:[1,0,0]
    v_pk_mul_f32 v[188:189], v[98:99], v[188:189]
    v_pk_mul_f32 v[190:191], v[100:101], v[190:191]
    v_pk_mul_f32 v[192:193], v[102:103], v[192:193]
    v_pk_mul_f32 v[194:195], v[104:105], v[194:195]
    v_exp_f32 v188, v188
    v_exp_f32 v189, v189
    v_exp_f32 v190, v190
    v_exp_f32 v191, v191
    v_exp_f32 v192, v192
    v_exp_f32 v193, v193
    v_exp_f32 v194, v194
    v_exp_f32 v195, v195
    v_pk_fma_f32 v[188:189], v[188:189], v[156:157], v[156:157] op_sel_hi:[1,0,0]
    v_pk_fma_f32 v[190:191], v[190:191], v[156:157], v[156:157] op_sel_hi:[1,0,0]
    v_pk_fma_f32 v[192:193], v[192:193], v[156:157], v[156:157] op_sel_hi:[1,0,0]
    v_pk_fma_f32 v[194:195], v[194:195], v[156:157], v[156:157] op_sel_hi:[1,0,0]
    v_rcp_f32 v188, v188
    v_rcp_f32 v189, v189
    v_rcp_f32 v190, v190
    v_rcp_f32 v191, v191
    v_rcp_f32 v192, v192
    v_rcp_f32 v193, v193
    v_rcp_f32 v194, v194
    v_rcp_f32 v195, v195
    v_pk_mul_f32 v[98:99], v[98:99], v[188:189]
    v_pk_mul_f32 v[100:101], v[100:101], v[190:191]
    v_pk_mul_f32 v[102:103], v[102:103], v[192:193]
    v_pk_mul_f32 v[104:105], v[104:105], v[194:195]
    v_cvt_pk_bf16_f32 v98, v98, v99
    v_cvt_pk_bf16_f32 v99, v100, v101
    v_cvt_pk_bf16_f32 v100, v102, v103
    v_cvt_pk_bf16_f32 v101, v104, v105
    buffer_store_dwordx4 v[98:101], v53, s[48:51], 0 offen sc1
    v_pk_mul_f32 v[196:197], v[106:107], v[106:107]
    v_pk_mul_f32 v[198:199], v[108:109], v[108:109]
    v_pk_mul_f32 v[200:201], v[110:111], v[110:111]
    v_pk_mul_f32 v[202:203], v[112:113], v[112:113]
    v_pk_fma_f32 v[196:197], v[196:197], v[154:155], v[158:159] op_sel_hi:[1,0,0]
    v_pk_fma_f32 v[198:199], v[198:199], v[154:155], v[158:159] op_sel_hi:[1,0,0]
    v_pk_fma_f32 v[200:201], v[200:201], v[154:155], v[158:159] op_sel_hi:[1,0,0]
    v_pk_fma_f32 v[202:203], v[202:203], v[154:155], v[158:159] op_sel_hi:[1,0,0]
    v_pk_mul_f32 v[196:197], v[106:107], v[196:197]
    v_pk_mul_f32 v[198:199], v[108:109], v[198:199]
    v_pk_mul_f32 v[200:201], v[110:111], v[200:201]
    v_pk_mul_f32 v[202:203], v[112:113], v[202:203]
    v_exp_f32 v196, v196
    v_exp_f32 v197, v197
    v_exp_f32 v198, v198
    v_exp_f32 v199, v199
    v_exp_f32 v200, v200
    v_exp_f32 v201, v201
    v_exp_f32 v202, v202
    v_exp_f32 v203, v203
    v_pk_fma_f32 v[196:197], v[196:197], v[156:157], v[156:157] op_sel_hi:[1,0,0]
    v_pk_fma_f32 v[198:199], v[198:199], v[156:157], v[156:157] op_sel_hi:[1,0,0]
    v_pk_fma_f32 v[200:201], v[200:201], v[156:157], v[156:157] op_sel_hi:[1,0,0]
    v_pk_fma_f32 v[202:203], v[202:203], v[156:157], v[156:157] op_sel_hi:[1,0,0]
    v_rcp_f32 v196, v196
    v_rcp_f32 v197, v197
    v_rcp_f32 v198, v198
    v_rcp_f32 v199, v199
    v_rcp_f32 v200, v200
    v_rcp_f32 v201, v201
    v_rcp_f32 v202, v202
    v_rcp_f32 v203, v203
    v_pk_mul_f32 v[106:107], v[106:107], v[196:197]
    v_pk_mul_f32 v[108:109], v[108:109], v[198:199]
    v_pk_mul_f32 v[110:111], v[110:111], v[200:201]
    v_pk_mul_f32 v[112:113], v[112:113], v[202:203]
    v_cvt_pk_bf16_f32 v106, v106, v107
    v_cvt_pk_bf16_f32 v107, v108, v109
    v_cvt_pk_bf16_f32 v108, v110, v111
    v_cvt_pk_bf16_f32 v109, v112, v113
    buffer_store_dwordx4 v[106:109], v53, s[48:51], 0 offen offset:2048 sc1
    v_pk_mul_f32 v[188:189], v[114:115], v[114:115]
    v_pk_mul_f32 v[190:191], v[116:117], v[116:117]
    v_pk_mul_f32 v[192:193], v[118:119], v[118:119]
    v_pk_mul_f32 v[194:195], v[120:121], v[120:121]
    v_pk_fma_f32 v[188:189], v[188:189], v[154:155], v[158:159] op_sel_hi:[1,0,0]
    v_pk_fma_f32 v[190:191], v[190:191], v[154:155], v[158:159] op_sel_hi:[1,0,0]
    v_pk_fma_f32 v[192:193], v[192:193], v[154:155], v[158:159] op_sel_hi:[1,0,0]
    v_pk_fma_f32 v[194:195], v[194:195], v[154:155], v[158:159] op_sel_hi:[1,0,0]
    v_pk_mul_f32 v[188:189], v[114:115], v[188:189]
    v_pk_mul_f32 v[190:191], v[116:117], v[190:191]
    v_pk_mul_f32 v[192:193], v[118:119], v[192:193]
    v_pk_mul_f32 v[194:195], v[120:121], v[194:195]
    v_exp_f32 v188, v188
    v_exp_f32 v189, v189
    v_exp_f32 v190, v190
    v_exp_f32 v191, v191
    v_exp_f32 v192, v192
    v_exp_f32 v193, v193
    v_exp_f32 v194, v194
    v_exp_f32 v195, v195
    v_pk_fma_f32 v[188:189], v[188:189], v[156:157], v[156:157] op_sel_hi:[1,0,0]
    v_pk_fma_f32 v[190:191], v[190:191], v[156:157], v[156:157] op_sel_hi:[1,0,0]
    v_pk_fma_f32 v[192:193], v[192:193], v[156:157], v[156:157] op_sel_hi:[1,0,0]
    v_pk_fma_f32 v[194:195], v[194:195], v[156:157], v[156:157] op_sel_hi:[1,0,0]
    v_rcp_f32 v188, v188
    v_rcp_f32 v189, v189
    v_rcp_f32 v190, v190
    v_rcp_f32 v191, v191
    v_rcp_f32 v192, v192
    v_rcp_f32 v193, v193
    v_rcp_f32 v194, v194
    v_rcp_f32 v195, v195
    v_pk_mul_f32 v[114:115], v[114:115], v[188:189]
    v_pk_mul_f32 v[116:117], v[116:117], v[190:191]
    v_pk_mul_f32 v[118:119], v[118:119], v[192:193]
    v_pk_mul_f32 v[120:121], v[120:121], v[194:195]
    v_cvt_pk_bf16_f32 v114, v114, v115
    v_cvt_pk_bf16_f32 v115, v116, v117
    v_cvt_pk_bf16_f32 v116, v118, v119
    v_cvt_pk_bf16_f32 v117, v120, v121
    buffer_store_dwordx4 v[114:117], v53, s[48:51], s10 offen sc1
    v_pk_mul_f32 v[196:197], v[122:123], v[122:123]
    v_pk_mul_f32 v[198:199], v[124:125], v[124:125]
    v_pk_mul_f32 v[200:201], v[126:127], v[126:127]
    v_pk_mul_f32 v[202:203], v[128:129], v[128:129]
    v_pk_fma_f32 v[196:197], v[196:197], v[154:155], v[158:159] op_sel_hi:[1,0,0]
    v_pk_fma_f32 v[198:199], v[198:199], v[154:155], v[158:159] op_sel_hi:[1,0,0]
    v_pk_fma_f32 v[200:201], v[200:201], v[154:155], v[158:159] op_sel_hi:[1,0,0]
    v_pk_fma_f32 v[202:203], v[202:203], v[154:155], v[158:159] op_sel_hi:[1,0,0]
    v_pk_mul_f32 v[196:197], v[122:123], v[196:197]
    v_pk_mul_f32 v[198:199], v[124:125], v[198:199]
    v_pk_mul_f32 v[200:201], v[126:127], v[200:201]
    v_pk_mul_f32 v[202:203], v[128:129], v[202:203]
    v_exp_f32 v196, v196
    v_exp_f32 v197, v197
    v_exp_f32 v198, v198
    v_exp_f32 v199, v199
    v_exp_f32 v200, v200
    v_exp_f32 v201, v201
    v_exp_f32 v202, v202
    v_exp_f32 v203, v203
    v_pk_fma_f32 v[196:197], v[196:197], v[156:157], v[156:157] op_sel_hi:[1,0,0]
    v_pk_fma_f32 v[198:199], v[198:199], v[156:157], v[156:157] op_sel_hi:[1,0,0]
    v_pk_fma_f32 v[200:201], v[200:201], v[156:157], v[156:157] op_sel_hi:[1,0,0]
    v_pk_fma_f32 v[202:203], v[202:203], v[156:157], v[156:157] op_sel_hi:[1,0,0]
    v_rcp_f32 v196, v196
    v_rcp_f32 v197, v197
    v_rcp_f32 v198, v198
    v_rcp_f32 v199, v199
    v_rcp_f32 v200, v200
    v_rcp_f32 v201, v201
    v_rcp_f32 v202, v202
    v_rcp_f32 v203, v203
    v_pk_mul_f32 v[122:123], v[122:123], v[196:197]
    v_pk_mul_f32 v[124:125], v[124:125], v[198:199]
    v_pk_mul_f32 v[126:127], v[126:127], v[200:201]
    v_pk_mul_f32 v[128:129], v[128:129], v[202:203]
    v_cvt_pk_bf16_f32 v122, v122, v123
    v_cvt_pk_bf16_f32 v123, v124, v125
    v_cvt_pk_bf16_f32 v124, v126, v127
    v_cvt_pk_bf16_f32 v125, v128, v129
    buffer_store_dwordx4 v[122:125], v53, s[48:51], s10 offen offset:2048 sc1
    s_waitcnt vmcnt(0)
L_merge3:
    s_barrier
    s_cmp_eq_u32 s56, 0
    s_cselect_b64 exec, 1, 0
    buffer_store_dwordx2 v[32:33], v30, s[48:51], 0 offen offset:256
    s_mov_b64 exec, -1
    v_lshlrev_b32 v48, 16, v164
    v_and_b32 v49, 0xffff0000, v164
    v_lshlrev_b32 v6, 16, v40
    v_and_b32 v7, 0xffff0000, v40
    v_pk_add_f32 v[48:49], v[48:49], v[6:7]
    v_lshlrev_b32 v50, 16, v165
    v_and_b32 v51, 0xffff0000, v165
    v_lshlrev_b32 v6, 16, v41
    v_and_b32 v7, 0xffff0000, v41
    v_pk_add_f32 v[50:51], v[50:51], v[6:7]
    v_lshlrev_b32 v52, 16, v166
    v_and_b32 v53, 0xffff0000, v166
    v_lshlrev_b32 v6, 16, v42
    v_and_b32 v7, 0xffff0000, v42
    v_pk_add_f32 v[52:53], v[52:53], v[6:7]
    v_lshlrev_b32 v54, 16, v167
    v_and_b32 v55, 0xffff0000, v167
    v_lshlrev_b32 v6, 16, v43
    v_and_b32 v7, 0xffff0000, v43
    v_pk_add_f32 v[54:55], v[54:55], v[6:7]
    v_lshlrev_b32 v56, 16, v168
    v_and_b32 v57, 0xffff0000, v168
    v_lshlrev_b32 v6, 16, v44
    v_and_b32 v7, 0xffff0000, v44
    v_pk_add_f32 v[56:57], v[56:57], v[6:7]
    v_lshlrev_b32 v58, 16, v169
    v_and_b32 v59, 0xffff0000, v169
    v_lshlrev_b32 v6, 16, v45
    v_and_b32 v7, 0xffff0000, v45
    v_pk_add_f32 v[58:59], v[58:59], v[6:7]
    v_lshlrev_b32 v60, 16, v170
    v_and_b32 v61, 0xffff0000, v170
    v_lshlrev_b32 v6, 16, v46
    v_and_b32 v7, 0xffff0000, v46
    v_pk_add_f32 v[60:61], v[60:61], v[6:7]
    v_lshlrev_b32 v62, 16, v171
    v_and_b32 v63, 0xffff0000, v171
    v_lshlrev_b32 v6, 16, v47
    v_and_b32 v7, 0xffff0000, v47
    v_pk_add_f32 v[62:63], v[62:63], v[6:7]
    v_lshlrev_b32 v8, 4, v0
    s_xor_b32 s4, s70, 0
    s_lshl_b32 s5, s59, 1
    s_add_u32 s4, s4, s5
    s_mul_i32 s4, s4, 229376
    s_mul_i32 s5, s56, 57344
    s_add_u32 s4, s4, s5
    s_add_u32 s4, s4, 10485760
    v_add_u32 v6, s4, v15
    s_xor_b32 s4, s70, 1
    s_lshl_b32 s5, s59, 1
    s_add_u32 s4, s4, s5
    s_mul_i32 s4, s4, 229376
    s_mul_i32 s5, s56, 57344
    s_add_u32 s4, s4, s5
    s_add_u32 s4, s4, 10485760
    v_add_u32 v7, s4, v15
    v_add_u32 v9, s21, v8
    s_xor_b32 s4, s56, 1
    s_lshl_b32 s4, s4, 14
    v_add_u32 v10, s4, v8
    s_xor_b32 s4, s56, 2
    s_lshl_b32 s4, s4, 14
    v_add_u32 v11, s4, v8
    s_xor_b32 s4, s56, 3
    s_lshl_b32 s4, s4, 14
    v_add_u32 v12, s4, v8
    s_lshl_b32 s4, s59, 6
    s_lshl_b32 s5, s70, 5
    s_add_u32 s4, s4, s5
    s_lshl_b32 s4, s4, 10
    s_lshl_b32 s5, s58, 7
    s_add_u32 s4, s4, s5
    s_lshl_b32 s5, s69, 6
    s_add_u32 s4, s4, s5
    v_and_b32 v15, 31, v0
    v_lshlrev_b32 v15, 10, v15
    v_lshrrev_b32 v8, 5, v0
    v_lshl_add_u32 v15, v8, 4, v15
    v_add_u32 v15, s4, v15
    ds_read_b64_tr_b16 v[34:35], v13 offset:0
    ds_read_b64_tr_b16 v[36:37], v13 offset:1024
    ds_read_b64_tr_b16 v[38:39], v14 offset:0
    ds_read_b64_tr_b16 v[40:41], v14 offset:1024
    ds_read_b64_tr_b16 v[112:113], v13 offset:2048
    ds_read_b64_tr_b16 v[114:115], v13 offset:3072
    ds_read_b64_tr_b16 v[116:117], v14 offset:2048
    ds_read_b64_tr_b16 v[118:119], v14 offset:3072
    v_mov_b32 v8, v29
    s_mov_b32 s16, 0
    s_mov_b64 exec, 65535
L_poll2:
    buffer_load_dwordx2 v[42:43], v8, s[48:51], 0 offen offset:256 sc1
    s_waitcnt vmcnt(0)
    v_cmp_ne_u64 vcc, s[94:95], v[42:43]
    s_cbranch_vccz L_ok2
    s_add_u32 s16, s16, 1
    s_cmp_lt_u32 s16, 64
    s_cbranch_scc1 L_poll2
    s_cmp_eq_u32 s16, 64
    s_cbranch_scc0 L_pub2
    s_cmp_eq_u32 s56, 0
    s_cselect_b64 exec, 1, 0
    buffer_store_dwordx2 v[32:33], v30, s[48:51], 0 offen offset:768 sc1
    s_mov_b64 exec, 65535
L_pub2:
    buffer_load_dwordx2 v[42:43], v8, s[48:51], 0 offen offset:768 sc1
    s_waitcnt vmcnt(0)
    v_cmp_ne_u64 vcc, s[94:95], v[42:43]
    s_cbranch_vccz L_ok2
    s_cmp_lt_u32 s16, 0x80000
    s_cbranch_scc1 L_poll2
L_ok2:
    s_mov_b64 exec, -1
    s_mov_b32 s9, 0
    buffer_load_dwordx4 a[0:3], v6, s[48:51], s9 offen sc1
    buffer_load_dwordx4 a[4:7], v7, s[48:51], s9 offen sc1
    buffer_load_dwordx4 a[8:11], v6, s[48:51], s9 offen offset:2048 sc1
    buffer_load_dwordx4 a[12:15], v7, s[48:51], s9 offen offset:2048 sc1
    s_mov_b32 s9, 4096
    buffer_load_dwordx4 a[16:19], v6, s[48:51], s9 offen sc1
    buffer_load_dwordx4 a[20:23], v7, s[48:51], s9 offen sc1
    buffer_load_dwordx4 a[24:27], v6, s[48:51], s9 offen offset:2048 sc1
    buffer_load_dwordx4 a[28:31], v7, s[48:51], s9 offen offset:2048 sc1
    s_mov_b32 s9, 8192
    buffer_load_dwordx4 a[32:35], v6, s[48:51], s9 offen sc1
    buffer_load_dwordx4 a[36:39], v7, s[48:51], s9 offen sc1
    buffer_load_dwordx4 a[40:43], v6, s[48:51], s9 offen offset:2048 sc1
    buffer_load_dwordx4 a[44:47], v7, s[48:51], s9 offen offset:2048 sc1
    s_mov_b32 s9, 12288
    buffer_load_dwordx4 a[48:51], v6, s[48:51], s9 offen sc1
    buffer_load_dwordx4 a[52:55], v7, s[48:51], s9 offen sc1
    s_waitcnt vmcnt(13) lgkmcnt(6)
    v_mfma_f32_32x32x16_bf16 v[48:63], v[34:37], a[0:3], v[48:63]
    buffer_load_dwordx4 a[56:59], v6, s[48:51], s9 offen offset:2048 sc1
    s_waitcnt vmcnt(13)
    v_mfma_f32_32x32x16_bf16 v[64:79], v[34:37], a[4:7], 0
    buffer_load_dwordx4 a[60:63], v7, s[48:51], s9 offen offset:2048 sc1
    ds_read_b64_tr_b16 v[120:121], v13 offset:4096
    ds_read_b64_tr_b16 v[122:123], v13 offset:5120
    ds_read_b64_tr_b16 v[124:125], v14 offset:4096
    ds_read_b64_tr_b16 v[126:127], v14 offset:5120
    s_waitcnt lgkmcnt(8)
    v_mfma_f32_32x32x16_bf16 v[80:95], v[38:41], a[0:3], 0
    v_mfma_f32_32x32x16_bf16 v[96:111], v[38:41], a[4:7], 0
    s_waitcnt vmcnt(13) lgkmcnt(6)
    v_mfma_f32_32x32x16_bf16 v[48:63], v[112:115], a[8:11], v[48:63]
    s_mov_b32 s9, 16384
    buffer_load_dwordx4 a[64:67], v6, s[48:51], s9 offen sc1
    s_waitcnt vmcnt(13)
    v_mfma_f32_32x32x16_bf16 v[64:79], v[112:115], a[12:15], v[64:79]
    buffer_load_dwordx4 a[68:71], v7, s[48:51], s9 offen sc1
    ds_read_b64_tr_b16 v[34:35], v16 offset:0
    ds_read_b64_tr_b16 v[36:37], v16 offset:1024
    ds_read_b64_tr_b16 v[38:39], v17 offset:0
    ds_read_b64_tr_b16 v[40:41], v17 offset:1024
    s_waitcnt lgkmcnt(8)
    v_mfma_f32_32x32x16_bf16 v[80:95], v[116:119], a[8:11], v[80:95]
    v_mfma_f32_32x32x16_bf16 v[96:111], v[116:119], a[12:15], v[96:111]
    s_waitcnt vmcnt(13) lgkmcnt(6)
    v_mfma_f32_32x32x16_bf16 v[48:63], v[120:123], a[16:19], v[48:63]
    buffer_load_dwordx4 a[72:75], v6, s[48:51], s9 offen offset:2048 sc1
    s_waitcnt vmcnt(13)
    v_mfma_f32_32x32x16_bf16 v[64:79], v[120:123], a[20:23], v[64:79]
    buffer_load_dwordx4 a[76:79], v7, s[48:51], s9 offen offset:2048 sc1
    ds_read_b64_tr_b16 v[112:113], v16 offset:2048
    ds_read_b64_tr_b16 v[114:115], v16 offset:3072
    ds_read_b64_tr_b16 v[116:117], v17 offset:2048
    ds_read_b64_tr_b16 v[118:119], v17 offset:3072
    s_add_u32 m0, s20, 0
    s_add_u32 s8, s23, 311296
    s_waitcnt lgkmcnt(8)
    v_mfma_f32_32x32x16_bf16 v[80:95], v[124:127], a[16:19], v[80:95]
    buffer_load_dwordx4 v22, s[44:47], s8 offen lds
    buffer_load_dwordx4 v23, s[44:47], s8 offen offset:1024 lds
    v_mfma_f32_32x32x16_bf16 v[96:111], v[124:127], a[20:23], v[96:111]
    buffer_load_dwordx4 v24, s[44:47], s8 offen offset:2048 lds
    buffer_load_dwordx4 v25, s[44:47], s8 offen offset:3072 lds
    s_waitcnt vmcnt(17) lgkmcnt(6)
    v_mfma_f32_32x32x16_bf16 v[48:63], v[34:37], a[24:27], v[48:63]
    s_mov_b32 s9, 20480
    buffer_load_dwordx4 a[80:83], v6, s[48:51], s9 offen sc1
    s_waitcnt vmcnt(17)
    v_mfma_f32_32x32x16_bf16 v[64:79], v[34:37], a[28:31], v[64:79]
    buffer_load_dwordx4 a[84:87], v7, s[48:51], s9 offen sc1
    ds_read_b64_tr_b16 v[120:121], v16 offset:4096
    ds_read_b64_tr_b16 v[122:123], v16 offset:5120
    ds_read_b64_tr_b16 v[124:125], v17 offset:4096
    ds_read_b64_tr_b16 v[126:127], v17 offset:5120
    s_add_u32 m0, s20, 4096
    s_add_u32 s8, s23, 344064
    s_waitcnt lgkmcnt(8)
    v_mfma_f32_32x32x16_bf16 v[80:95], v[38:41], a[24:27], v[80:95]
    buffer_load_dwordx4 v22, s[44:47], s8 offen lds
    buffer_load_dwordx4 v23, s[44:47], s8 offen offset:1024 lds
    v_mfma_f32_32x32x16_bf16 v[96:111], v[38:41], a[28:31], v[96:111]
    s_waitcnt vmcnt(19) lgkmcnt(6)
    v_mfma_f32_32x32x16_bf16 v[48:63], v[112:115], a[32:35], v[48:63]
    buffer_load_dwordx4 a[88:91], v6, s[48:51], s9 offen offset:2048 sc1
    s_waitcnt vmcnt(19)
    v_mfma_f32_32x32x16_bf16 v[64:79], v[112:115], a[36:39], v[64:79]
    buffer_load_dwordx4 a[92:95], v7, s[48:51], s9 offen offset:2048 sc1
    ds_read_b64_tr_b16 v[34:35], v16 offset:6144
    ds_read_b64_tr_b16 v[36:37], v16 offset:7168
    ds_read_b64_tr_b16 v[38:39], v17 offset:6144
    ds_read_b64_tr_b16 v[40:41], v17 offset:7168
    s_waitcnt lgkmcnt(8)
    v_mfma_f32_32x32x16_bf16 v[80:95], v[116:119], a[32:35], v[80:95]
    v_mfma_f32_32x32x16_bf16 v[96:111], v[116:119], a[36:39], v[96:111]
    s_waitcnt vmcnt(19) lgkmcnt(6)
    v_mfma_f32_32x32x16_bf16 v[48:63], v[120:123], a[40:43], v[48:63]
    s_mov_b32 s9, 24576
    buffer_load_dwordx4 a[96:99], v6, s[48:51], s9 offen sc1
    s_waitcnt vmcnt(19)
    v_mfma_f32_32x32x16_bf16 v[64:79], v[120:123], a[44:47], v[64:79]
    buffer_load_dwordx4 a[100:103], v7, s[48:51], s9 offen sc1
    ds_read_b64_tr_b16 v[112:113], v16 offset:8192
    ds_read_b64_tr_b16 v[114:115], v16 offset:9216
    ds_read_b64_tr_b16 v[116:117], v17 offset:8192
    ds_read_b64_tr_b16 v[118:119], v17 offset:9216
    s_add_u32 m0, s21, 0
    s_add_u32 s8, s23, 360448
    s_waitcnt lgkmcnt(8)
    v_mfma_f32_32x32x16_bf16 v[80:95], v[124:127], a[40:43], v[80:95]
    buffer_load_dwordx4 v22, s[44:47], s8 offen lds
    buffer_load_dwordx4 v23, s[44:47], s8 offen offset:1024 lds
    v_mfma_f32_32x32x16_bf16 v[96:111], v[124:127], a[44:47], v[96:111]
    buffer_load_dwordx4 v24, s[44:47], s8 offen offset:2048 lds
    buffer_load_dwordx4 v25, s[44:47], s8 offen offset:3072 lds
    s_waitcnt vmcnt(23) lgkmcnt(6)
    v_mfma_f32_32x32x16_bf16 v[48:63], v[34:37], a[48:51], v[48:63]
    buffer_load_dwordx4 a[104:107], v6, s[48:51], s9 offen offset:2048 sc1
    s_waitcnt vmcnt(23)
    v_mfma_f32_32x32x16_bf16 v[64:79], v[34:37], a[52:55], v[64:79]
    buffer_load_dwordx4 a[108:111], v7, s[48:51], s9 offen offset:2048 sc1
    ds_read_b64_tr_b16 v[120:121], v16 offset:10240
    ds_read_b64_tr_b16 v[122:123], v16 offset:11264
    ds_read_b64_tr_b16 v[124:125], v17 offset:10240
    ds_read_b64_tr_b16 v[126:127], v17 offset:11264
    s_waitcnt lgkmcnt(8)
    v_mfma_f32_32x32x16_bf16 v[80:95], v[38:41], a[48:51], v[80:95]
    v_mfma_f32_32x32x16_bf16 v[96:111], v[38:41], a[52:55], v[96:111]
    s_waitcnt vmcnt(23) lgkmcnt(6)
    v_mfma_f32_32x32x16_bf16 v[48:63], v[112:115], a[56:59], v[48:63]
    s_mov_b32 s9, 28672
    buffer_load_dwordx4 a[112:115], v6, s[48:51], s9 offen sc1
    s_waitcnt vmcnt(23)
    v_mfma_f32_32x32x16_bf16 v[64:79], v[112:115], a[60:63], v[64:79]
    buffer_load_dwordx4 a[116:119], v7, s[48:51], s9 offen sc1
    ds_read_b64_tr_b16 v[34:35], v16 offset:12288
    ds_read_b64_tr_b16 v[36:37], v16 offset:13312
    ds_read_b64_tr_b16 v[38:39], v17 offset:12288
    ds_read_b64_tr_b16 v[40:41], v17 offset:13312
    s_add_u32 m0, s21, 4096
    s_add_u32 s8, s23, 393216
    s_waitcnt lgkmcnt(8)
    v_mfma_f32_32x32x16_bf16 v[80:95], v[116:119], a[56:59], v[80:95]
    buffer_load_dwordx4 v22, s[44:47], s8 offen lds
    buffer_load_dwordx4 v23, s[44:47], s8 offen offset:1024 lds
    v_mfma_f32_32x32x16_bf16 v[96:111], v[116:119], a[60:63], v[96:111]
    buffer_load_dwordx4 v24, s[44:47], s8 offen offset:2048 lds
    buffer_load_dwordx4 v25, s[44:47], s8 offen offset:3072 lds
    s_waitcnt vmcnt(27) lgkmcnt(6)
    v_mfma_f32_32x32x16_bf16 v[48:63], v[120:123], a[64:67], v[48:63]
    buffer_load_dwordx4 a[120:123], v6, s[48:51], s9 offen offset:2048 sc1
    s_waitcnt vmcnt(27)
    v_mfma_f32_32x32x16_bf16 v[64:79], v[120:123], a[68:71], v[64:79]
    buffer_load_dwordx4 a[124:127], v7, s[48:51], s9 offen offset:2048 sc1
    ds_read_b64_tr_b16 v[112:113], v16 offset:14336
    ds_read_b64_tr_b16 v[114:115], v16 offset:15360
    ds_read_b64_tr_b16 v[116:117], v17 offset:14336
    ds_read_b64_tr_b16 v[118:119], v17 offset:15360
    s_waitcnt lgkmcnt(8)
    v_mfma_f32_32x32x16_bf16 v[80:95], v[124:127], a[64:67], v[80:95]
    v_mfma_f32_32x32x16_bf16 v[96:111], v[124:127], a[68:71], v[96:111]
    s_waitcnt vmcnt(27) lgkmcnt(6)
    v_mfma_f32_32x32x16_bf16 v[48:63], v[34:37], a[72:75], v[48:63]
    s_mov_b32 s9, 32768
    buffer_load_dwordx4 a[128:131], v6, s[48:51], s9 offen sc1
    s_waitcnt vmcnt(27)
    v_mfma_f32_32x32x16_bf16 v[64:79], v[34:37], a[76:79], v[64:79]
    buffer_load_dwordx4 a[132:135], v7, s[48:51], s9 offen sc1
    ds_read_b64_tr_b16 v[120:121], v26 offset:0
    ds_read_b64_tr_b16 v[122:123], v26 offset:1024
    ds_read_b64_tr_b16 v[124:125], v27 offset:0
    ds_read_b64_tr_b16 v[126:127], v27 offset:1024
    s_add_u32 m0, s21, 8192
    s_add_u32 s8, s23, 425984
    s_waitcnt lgkmcnt(8)
    v_mfma_f32_32x32x16_bf16 v[80:95], v[38:41], a[72:75], v[80:95]
    buffer_load_dwordx4 v22, s[44:47], s8 offen lds
    buffer_load_dwordx4 v23, s[44:47], s8 offen offset:1024 lds
    v_mfma_f32_32x32x16_bf16 v[96:111], v[38:41], a[76:79], v[96:111]
    buffer_load_dwordx4 v24, s[44:47], s8 offen offset:2048 lds
    buffer_load_dwordx4 v25, s[44:47], s8 offen offset:3072 lds
    s_waitcnt vmcnt(27) lgkmcnt(6)
    v_mfma_f32_32x32x16_bf16 v[48:63], v[112:115], a[80:83], v[48:63]
    buffer_load_dwordx4 a[136:139], v6, s[48:51], s9 offen offset:2048 sc1
    s_waitcnt vmcnt(27)
    v_mfma_f32_32x32x16_bf16 v[64:79], v[112:115], a[84:87], v[64:79]
    buffer_load_dwordx4 a[140:143], v7, s[48:51], s9 offen offset:2048 sc1
    ds_read_b64_tr_b16 v[34:35], v26 offset:2048
    ds_read_b64_tr_b16 v[36:37], v26 offset:3072
    ds_read_b64_tr_b16 v[38:39], v27 offset:2048
    ds_read_b64_tr_b16 v[40:41], v27 offset:3072
    s_waitcnt lgkmcnt(8)
    v_mfma_f32_32x32x16_bf16 v[80:95], v[116:119], a[80:83], v[80:95]
    v_mfma_f32_32x32x16_bf16 v[96:111], v[116:119], a[84:87], v[96:111]
    s_waitcnt vmcnt(25) lgkmcnt(6)
    v_mfma_f32_32x32x16_bf16 v[48:63], v[120:123], a[88:91], v[48:63]
    s_mov_b32 s9, 36864
    buffer_load_dwordx4 a[144:147], v6, s[48:51], s9 offen sc1
    s_waitcnt vmcnt(25)
    v_mfma_f32_32x32x16_bf16 v[64:79], v[120:123], a[92:95], v[64:79]
    buffer_load_dwordx4 a[148:151], v7, s[48:51], s9 offen sc1
    ds_read_b64_tr_b16 v[112:113], v26 offset:4096
    ds_read_b64_tr_b16 v[114:115], v26 offset:5120
    ds_read_b64_tr_b16 v[116:117], v27 offset:4096
    ds_read_b64_tr_b16 v[118:119], v27 offset:5120
    s_waitcnt lgkmcnt(8)
    v_mfma_f32_32x32x16_bf16 v[80:95], v[124:127], a[88:91], v[80:95]
    v_mfma_f32_32x32x16_bf16 v[96:111], v[124:127], a[92:95], v[96:111]
    s_waitcnt vmcnt(25) lgkmcnt(6)
    v_mfma_f32_32x32x16_bf16 v[48:63], v[34:37], a[96:99], v[48:63]
    buffer_load_dwordx4 a[152:155], v6, s[48:51], s9 offen offset:2048 sc1
    s_waitcnt vmcnt(25)
    v_mfma_f32_32x32x16_bf16 v[64:79], v[34:37], a[100:103], v[64:79]
    buffer_load_dwordx4 a[156:159], v7, s[48:51], s9 offen offset:2048 sc1
    ds_read_b64_tr_b16 v[120:121], v26 offset:6144
    ds_read_b64_tr_b16 v[122:123], v26 offset:7168
    ds_read_b64_tr_b16 v[124:125], v27 offset:6144
    ds_read_b64_tr_b16 v[126:127], v27 offset:7168
    s_waitcnt lgkmcnt(8)
    v_mfma_f32_32x32x16_bf16 v[80:95], v[38:41], a[96:99], v[80:95]
    v_mfma_f32_32x32x16_bf16 v[96:111], v[38:41], a[100:103], v[96:111]
    s_waitcnt vmcnt(21) lgkmcnt(6)
    v_mfma_f32_32x32x16_bf16 v[48:63], v[112:115], a[104:107], v[48:63]
    s_mov_b32 s9, 40960
    buffer_load_dwordx4 a[160:163], v6, s[48:51], s9 offen sc1
    s_waitcnt vmcnt(21)
    v_mfma_f32_32x32x16_bf16 v[64:79], v[112:115], a[108:111], v[64:79]
    buffer_load_dwordx4 a[164:167], v7, s[48:51], s9 offen sc1
    ds_read_b64_tr_b16 v[34:35], v26 offset:8192
    ds_read_b64_tr_b16 v[36:37], v26 offset:9216
    ds_read_b64_tr_b16 v[38:39], v27 offset:8192
    ds_read_b64_tr_b16 v[40:41], v27 offset:9216
    s_waitcnt lgkmcnt(8)
    v_mfma_f32_32x32x16_bf16 v[80:95], v[116:119], a[104:107], v[80:95]
    v_mfma_f32_32x32x16_bf16 v[96:111], v[116:119], a[108:111], v[96:111]
    s_waitcnt vmcnt(21) lgkmcnt(6)
    v_mfma_f32_32x32x16_bf16 v[48:63], v[120:123], a[112:115], v[48:63]
    buffer_load_dwordx4 a[168:171], v6, s[48:51], s9 offen offset:2048 sc1
    s_waitcnt vmcnt(21)
    v_mfma_f32_32x32x16_bf16 v[64:79], v[120:123], a[116:119], v[64:79]
    buffer_load_dwordx4 a[172:175], v7, s[48:51], s9 offen offset:2048 sc1
    ds_read_b64_tr_b16 v[112:113], v26 offset:10240
    ds_read_b64_tr_b16 v[114:115], v26 offset:11264
    ds_read_b64_tr_b16 v[116:117], v27 offset:10240
    ds_read_b64_tr_b16 v[118:119], v27 offset:11264
    s_waitcnt lgkmcnt(8)
    v_mfma_f32_32x32x16_bf16 v[80:95], v[124:127], a[112:115], v[80:95]
    v_mfma_f32_32x32x16_bf16 v[96:111], v[124:127], a[116:119], v[96:111]
    s_waitcnt vmcnt(17) lgkmcnt(6)
    v_mfma_f32_32x32x16_bf16 v[48:63], v[34:37], a[120:123], v[48:63]
    s_mov_b32 s9, 45056
    buffer_load_dwordx4 a[176:179], v6, s[48:51], s9 offen sc1
    s_waitcnt vmcnt(17)
    v_mfma_f32_32x32x16_bf16 v[64:79], v[34:37], a[124:127], v[64:79]
    buffer_load_dwordx4 a[180:183], v7, s[48:51], s9 offen sc1
    ds_read_b64_tr_b16 v[120:121], v26 offset:12288
    ds_read_b64_tr_b16 v[122:123], v26 offset:13312
    ds_read_b64_tr_b16 v[124:125], v27 offset:12288
    ds_read_b64_tr_b16 v[126:127], v27 offset:13312
    s_waitcnt lgkmcnt(8)
    v_mfma_f32_32x32x16_bf16 v[80:95], v[38:41], a[120:123], v[80:95]
    v_mfma_f32_32x32x16_bf16 v[96:111], v[38:41], a[124:127], v[96:111]
    s_waitcnt vmcnt(17) lgkmcnt(6)
    v_mfma_f32_32x32x16_bf16 v[48:63], v[112:115], a[128:131], v[48:63]
    buffer_load_dwordx4 a[184:187], v6, s[48:51], s9 offen offset:2048 sc1
    s_waitcnt vmcnt(17)
    v_mfma_f32_32x32x16_bf16 v[64:79], v[112:115], a[132:135], v[64:79]
    buffer_load_dwordx4 a[188:191], v7, s[48:51], s9 offen offset:2048 sc1
    ds_read_b64_tr_b16 v[34:35], v26 offset:14336
    ds_read_b64_tr_b16 v[36:37], v26 offset:15360
    ds_read_b64_tr_b16 v[38:39], v27 offset:14336
    ds_read_b64_tr_b16 v[40:41], v27 offset:15360
    s_waitcnt lgkmcnt(8)
    v_mfma_f32_32x32x16_bf16 v[80:95], v[116:119], a[128:131], v[80:95]
    v_mfma_f32_32x32x16_bf16 v[96:111], v[116:119], a[132:135], v[96:111]
    s_waitcnt vmcnt(13) lgkmcnt(6)
    v_mfma_f32_32x32x16_bf16 v[48:63], v[120:123], a[136:139], v[48:63]
    s_mov_b32 s9, 49152
    buffer_load_dwordx4 a[192:195], v6, s[48:51], s9 offen sc1
    s_waitcnt vmcnt(13)
    v_mfma_f32_32x32x16_bf16 v[64:79], v[120:123], a[140:143], v[64:79]
    buffer_load_dwordx4 a[196:199], v7, s[48:51], s9 offen sc1
    ds_read_b64_tr_b16 v[112:113], v13 offset:0
    ds_read_b64_tr_b16 v[114:115], v13 offset:1024
    ds_read_b64_tr_b16 v[116:117], v14 offset:0
    ds_read_b64_tr_b16 v[118:119], v14 offset:1024
    s_waitcnt lgkmcnt(8)
    v_mfma_f32_32x32x16_bf16 v[80:95], v[124:127], a[136:139], v[80:95]
    v_mfma_f32_32x32x16_bf16 v[96:111], v[124:127], a[140:143], v[96:111]
    s_waitcnt vmcnt(13) lgkmcnt(6)
    v_mfma_f32_32x32x16_bf16 v[48:63], v[34:37], a[144:147], v[48:63]
    buffer_load_dwordx4 a[200:203], v6, s[48:51], s9 offen offset:2048 sc1
    s_waitcnt vmcnt(13)
    v_mfma_f32_32x32x16_bf16 v[64:79], v[34:37], a[148:151], v[64:79]
    buffer_load_dwordx4 a[204:207], v7, s[48:51], s9 offen offset:2048 sc1
    ds_read_b64_tr_b16 v[120:121], v13 offset:2048
    ds_read_b64_tr_b16 v[122:123], v13 offset:3072
    ds_read_b64_tr_b16 v[124:125], v14 offset:2048
    ds_read_b64_tr_b16 v[126:127], v14 offset:3072
    s_waitcnt lgkmcnt(8)
    v_mfma_f32_32x32x16_bf16 v[80:95], v[38:41], a[144:147], v[80:95]
    v_mfma_f32_32x32x16_bf16 v[96:111], v[38:41], a[148:151], v[96:111]
    s_waitcnt vmcnt(13) lgkmcnt(6)
    v_mfma_f32_32x32x16_bf16 v[48:63], v[112:115], a[152:155], v[48:63]
    s_mov_b32 s9, 53248
    buffer_load_dwordx4 a[208:211], v6, s[48:51], s9 offen sc1
    s_waitcnt vmcnt(13)
    v_mfma_f32_32x32x16_bf16 v[64:79], v[112:115], a[156:159], v[64:79]
    buffer_load_dwordx4 a[212:215], v7, s[48:51], s9 offen sc1
    ds_read_b64_tr_b16 v[34:35], v13 offset:4096
    ds_read_b64_tr_b16 v[36:37], v13 offset:5120
    ds_read_b64_tr_b16 v[38:39], v14 offset:4096
    ds_read_b64_tr_b16 v[40:41], v14 offset:5120
    s_waitcnt lgkmcnt(8)
    v_mfma_f32_32x32x16_bf16 v[80:95], v[116:119], a[152:155], v[80:95]
    v_mfma_f32_32x32x16_bf16 v[96:111], v[116:119], a[156:159], v[96:111]
    s_waitcnt vmcnt(13) lgkmcnt(6)
    v_mfma_f32_32x32x16_bf16 v[48:63], v[120:123], a[160:163], v[48:63]
    buffer_load_dwordx4 a[216:219], v6, s[48:51], s9 offen offset:2048 sc1
    s_waitcnt vmcnt(13)
    v_mfma_f32_32x32x16_bf16 v[64:79], v[120:123], a[164:167], v[64:79]
    buffer_load_dwordx4 a[220:223], v7, s[48:51], s9 offen offset:2048 sc1
    ds_read_b64_tr_b16 v[112:113], v16 offset:0
    ds_read_b64_tr_b16 v[114:115], v16 offset:1024
    ds_read_b64_tr_b16 v[116:117], v17 offset:0
    ds_read_b64_tr_b16 v[118:119], v17 offset:1024
    s_waitcnt lgkmcnt(8)
    v_mfma_f32_32x32x16_bf16 v[80:95], v[124:127], a[160:163], v[80:95]
    v_mfma_f32_32x32x16_bf16 v[96:111], v[124:127], a[164:167], v[96:111]
    s_waitcnt vmcnt(13) lgkmcnt(6)
    v_mfma_f32_32x32x16_bf16 v[48:63], v[34:37], a[168:171], v[48:63]
    s_waitcnt vmcnt(12)
    v_mfma_f32_32x32x16_bf16 v[64:79], v[34:37], a[172:175], v[64:79]
    ds_read_b64_tr_b16 v[120:121], v16 offset:2048
    ds_read_b64_tr_b16 v[122:123], v16 offset:3072
    ds_read_b64_tr_b16 v[124:125], v17 offset:2048
    ds_read_b64_tr_b16 v[126:127], v17 offset:3072
    s_waitcnt lgkmcnt(8)
    v_mfma_f32_32x32x16_bf16 v[80:95], v[38:41], a[168:171], v[80:95]
    v_mfma_f32_32x32x16_bf16 v[96:111], v[38:41], a[172:175], v[96:111]
    s_waitcnt vmcnt(11) lgkmcnt(6)
    v_mfma_f32_32x32x16_bf16 v[48:63], v[112:115], a[176:179], v[48:63]
    s_waitcnt vmcnt(10)
    v_mfma_f32_32x32x16_bf16 v[64:79], v[112:115], a[180:183], v[64:79]
    ds_read_b64_tr_b16 v[34:35], v16 offset:4096
    ds_read_b64_tr_b16 v[36:37], v16 offset:5120
    ds_read_b64_tr_b16 v[38:39], v17 offset:4096
    ds_read_b64_tr_b16 v[40:41], v17 offset:5120
    s_waitcnt lgkmcnt(8)
    v_mfma_f32_32x32x16_bf16 v[80:95], v[116:119], a[176:179], v[80:95]
    v_mfma_f32_32x32x16_bf16 v[96:111], v[116:119], a[180:183], v[96:111]
    s_waitcnt vmcnt(9) lgkmcnt(6)
    v_mfma_f32_32x32x16_bf16 v[48:63], v[120:123], a[184:187], v[48:63]
    s_waitcnt vmcnt(8)
    v_mfma_f32_32x32x16_bf16 v[64:79], v[120:123], a[188:191], v[64:79]
    ds_read_b64_tr_b16 v[112:113], v16 offset:6144
    ds_read_b64_tr_b16 v[114:115], v16 offset:7168
    ds_read_b64_tr_b16 v[116:117], v17 offset:6144
    ds_read_b64_tr_b16 v[118:119], v17 offset:7168
    s_waitcnt lgkmcnt(8)
    v_mfma_f32_32x32x16_bf16 v[80:95], v[124:127], a[184:187], v[80:95]
    v_mfma_f32_32x32x16_bf16 v[96:111], v[124:127], a[188:191], v[96:111]
    s_waitcnt vmcnt(7) lgkmcnt(6)
    v_mfma_f32_32x32x16_bf16 v[48:63], v[34:37], a[192:195], v[48:63]
    s_waitcnt vmcnt(6)
    v_mfma_f32_32x32x16_bf16 v[64:79], v[34:37], a[196:199], v[64:79]
    ds_read_b64_tr_b16 v[120:121], v16 offset:8192
    ds_read_b64_tr_b16 v[122:123], v16 offset:9216
    ds_read_b64_tr_b16 v[124:125], v17 offset:8192
    ds_read_b64_tr_b16 v[126:127], v17 offset:9216
    s_waitcnt lgkmcnt(8)
    v_mfma_f32_32x32x16_bf16 v[80:95], v[38:41], a[192:195], v[80:95]
    v_mfma_f32_32x32x16_bf16 v[96:111], v[38:41], a[196:199], v[96:111]
    s_waitcnt vmcnt(5) lgkmcnt(6)
    v_mfma_f32_32x32x16_bf16 v[48:63], v[112:115], a[200:203], v[48:63]
    s_waitcnt vmcnt(4)
    v_mfma_f32_32x32x16_bf16 v[64:79], v[112:115], a[204:207], v[64:79]
    ds_read_b64_tr_b16 v[34:35], v16 offset:10240
    ds_read_b64_tr_b16 v[36:37], v16 offset:11264
    ds_read_b64_tr_b16 v[38:39], v17 offset:10240
    ds_read_b64_tr_b16 v[40:41], v17 offset:11264
    s_waitcnt lgkmcnt(8)
    v_mfma_f32_32x32x16_bf16 v[80:95], v[116:119], a[200:203], v[80:95]
    v_mfma_f32_32x32x16_bf16 v[96:111], v[116:119], a[204:207], v[96:111]
    s_waitcnt vmcnt(3) lgkmcnt(6)
    v_mfma_f32_32x32x16_bf16 v[48:63], v[120:123], a[208:211], v[48:63]
    s_waitcnt vmcnt(2)
    v_mfma_f32_32x32x16_bf16 v[64:79], v[120:123], a[212:215], v[64:79]
    s_waitcnt lgkmcnt(4)
    v_mfma_f32_32x32x16_bf16 v[80:95], v[124:127], a[208:211], v[80:95]
    v_mfma_f32_32x32x16_bf16 v[96:111], v[124:127], a[212:215], v[96:111]
    s_waitcnt vmcnt(1) lgkmcnt(2)
    v_mfma_f32_32x32x16_bf16 v[48:63], v[34:37], a[216:219], v[48:63]
    s_waitcnt vmcnt(0)
    v_mfma_f32_32x32x16_bf16 v[64:79], v[34:37], a[220:223], v[64:79]
    s_waitcnt lgkmcnt(0)
    v_mfma_f32_32x32x16_bf16 v[80:95], v[38:41], a[216:219], v[80:95]
    v_mfma_f32_32x32x16_bf16 v[96:111], v[38:41], a[220:223], v[96:111]
    s_nop 8
    ds_write_b128 v9, v[64:67] offset:0
    ds_write_b128 v9, v[68:71] offset:1024
    ds_write_b128 v9, v[72:75] offset:2048
    ds_write_b128 v9, v[76:79] offset:3072
    ds_write_b128 v9, v[80:83] offset:4096
    ds_write_b128 v9, v[84:87] offset:5120
    ds_write_b128 v9, v[88:91] offset:6144
    ds_write_b128 v9, v[92:95] offset:7168
    ds_write_b128 v9, v[96:99] offset:8192
    ds_write_b128 v9, v[100:103] offset:9216
    ds_write_b128 v9, v[104:107] offset:10240
    ds_write_b128 v9, v[108:111] offset:11264
    s_cmp_eq_u32 s56, 0
    s_cselect_b64 exec, 1, 0
    buffer_store_dwordx2 v[32:33], v30, s[48:51], 0 offen offset:768 sc1
    s_mov_b64 exec, -1
    s_waitcnt lgkmcnt(0)
    s_barrier
    ds_read_b128 v[64:67], v10 offset:0
    ds_read_b128 v[68:71], v10 offset:1024
    ds_read_b128 v[72:75], v10 offset:2048
    ds_read_b128 v[76:79], v10 offset:3072
    ds_read_b128 v[80:83], v11 offset:4096
    ds_read_b128 v[84:87], v11 offset:5120
    ds_read_b128 v[88:91], v11 offset:6144
    ds_read_b128 v[92:95], v11 offset:7168
    ds_read_b128 v[96:99], v12 offset:8192
    ds_read_b128 v[100:103], v12 offset:9216
    ds_read_b128 v[104:107], v12 offset:10240
    ds_read_b128 v[108:111], v12 offset:11264
    s_waitcnt lgkmcnt(11)
    v_pk_add_f32 v[48:49], v[48:49], v[64:65]
    v_pk_add_f32 v[50:51], v[50:51], v[66:67]
    s_waitcnt lgkmcnt(10)
    v_pk_add_f32 v[52:53], v[52:53], v[68:69]
    v_pk_add_f32 v[54:55], v[54:55], v[70:71]
    s_waitcnt lgkmcnt(9)
    v_pk_add_f32 v[56:57], v[56:57], v[72:73]
    v_pk_add_f32 v[58:59], v[58:59], v[74:75]
    s_waitcnt lgkmcnt(8)
    v_pk_add_f32 v[60:61], v[60:61], v[76:77]
    v_pk_add_f32 v[62:63], v[62:63], v[78:79]
    s_waitcnt lgkmcnt(7)
    v_pk_add_f32 v[48:49], v[48:49], v[80:81]
    v_pk_add_f32 v[50:51], v[50:51], v[82:83]
    s_waitcnt lgkmcnt(6)
    v_pk_add_f32 v[52:53], v[52:53], v[84:85]
    v_pk_add_f32 v[54:55], v[54:55], v[86:87]
    s_waitcnt lgkmcnt(5)
    v_pk_add_f32 v[56:57], v[56:57], v[88:89]
    v_pk_add_f32 v[58:59], v[58:59], v[90:91]
    s_waitcnt lgkmcnt(4)
    v_pk_add_f32 v[60:61], v[60:61], v[92:93]
    v_pk_add_f32 v[62:63], v[62:63], v[94:95]
    s_waitcnt lgkmcnt(3)
    v_pk_add_f32 v[48:49], v[48:49], v[96:97]
    v_pk_add_f32 v[50:51], v[50:51], v[98:99]
    s_waitcnt lgkmcnt(2)
    v_pk_add_f32 v[52:53], v[52:53], v[100:101]
    v_pk_add_f32 v[54:55], v[54:55], v[102:103]
    s_waitcnt lgkmcnt(1)
    v_pk_add_f32 v[56:57], v[56:57], v[104:105]
    v_pk_add_f32 v[58:59], v[58:59], v[106:107]
    s_waitcnt lgkmcnt(0)
    v_pk_add_f32 v[60:61], v[60:61], v[108:109]
    v_pk_add_f32 v[62:63], v[62:63], v[110:111]
    v_cvt_pk_bf16_f32 v48, v48, v49
    v_cvt_pk_bf16_f32 v49, v50, v51
    v_cvt_pk_bf16_f32 v50, v52, v53
    v_cvt_pk_bf16_f32 v51, v54, v55
    v_cvt_pk_bf16_f32 v52, v56, v57
    v_cvt_pk_bf16_f32 v53, v58, v59
    v_cvt_pk_bf16_f32 v54, v60, v61
    v_cvt_pk_bf16_f32 v55, v62, v63
    v_permlane32_swap_b32 v48, v50
    v_permlane32_swap_b32 v49, v51
    v_permlane32_swap_b32 v52, v54
    v_permlane32_swap_b32 v53, v55
    buffer_store_dwordx4 v[48:51], v15, s[52:55], 0 offen
    buffer_store_dwordx4 v[52:55], v15, s[52:55], 0 offen offset:32
    s_lshl_b32 s4, s61, 10
    s_add_u32 s4, s4, 9437184
    v_mov_b32 v9, s4
    s_or_b32 s5, s60, s56
    s_cmp_eq_u32 s5, 0
    s_cselect_b64 exec, 1, 0
    buffer_store_dwordx2 v[32:33], v9, s[48:51], 0 offen offset:896
    s_mov_b64 exec, -1
L_end:
    s_endpgm
L_idle3:
    s_cmp_eq_u32 s56, 0
    s_cselect_b64 exec, 1, 0
    buffer_store_dwordx2 v[32:33], v30, s[48:51], 0 offen offset:640 sc1
    s_mov_b64 exec, -1
    s_add_u32 m0, s20, 0
    s_add_u32 s8, s23, 0
    buffer_load_dwordx4 v22, s[44:47], s8 offen lds
    buffer_load_dwordx4 v23, s[44:47], s8 offen offset:1024 lds
    buffer_load_dwordx4 v24, s[44:47], s8 offen offset:2048 lds
    buffer_load_dwordx4 v25, s[44:47], s8 offen offset:3072 lds
    s_add_u32 m0, s20, 4096
    s_add_u32 s8, s23, 32768
    buffer_load_dwordx4 v22, s[44:47], s8 offen lds
    buffer_load_dwordx4 v23, s[44:47], s8 offen offset:1024 lds
    s_add_u32 m0, s21, 0
    s_add_u32 s8, s23, 49152
    buffer_load_dwordx4 v22, s[44:47], s8 offen lds
    buffer_load_dwordx4 v23, s[44:47], s8 offen offset:1024 lds
    buffer_load_dwordx4 v24, s[44:47], s8 offen offset:2048 lds
    buffer_load_dwordx4 v25, s[44:47], s8 offen offset:3072 lds
    s_add_u32 m0, s21, 4096
    s_add_u32 s8, s23, 81920
    buffer_load_dwordx4 v22, s[44:47], s8 offen lds
    buffer_load_dwordx4 v23, s[44:47], s8 offen offset:1024 lds
    buffer_load_dwordx4 v24, s[44:47], s8 offen offset:2048 lds
    buffer_load_dwordx4 v25, s[44:47], s8 offen offset:3072 lds
    s_add_u32 m0, s21, 8192
    s_add_u32 s8, s23, 114688
    buffer_load_dwordx4 v22, s[44:47], s8 offen lds
    buffer_load_dwordx4 v23, s[44:47], s8 offen offset:1024 lds
    buffer_load_dwordx4 v24, s[44:47], s8 offen offset:2048 lds
    buffer_load_dwordx4 v25, s[44:47], s8 offen offset:3072 lds
    s_add_u32 m0, s21, 12288
    s_add_u32 s8, s23, 147456
    buffer_load_dwordx4 v22, s[44:47], s8 offen lds
    buffer_load_dwordx4 v23, s[44:47], s8 offen offset:1024 lds
    buffer_load_dwordx4 v24, s[44:47], s8 offen offset:2048 lds
    buffer_load_dwordx4 v25, s[44:47], s8 offen offset:3072 lds
    s_add_u32 m0, s22, 0
    s_add_u32 s8, s23, 180224
    buffer_load_dwordx4 v22, s[44:47], s8 offen lds
    buffer_load_dwordx4 v23, s[44:47], s8 offen offset:1024 lds
    buffer_load_dwordx4 v24, s[44:47], s8 offen offset:2048 lds
    buffer_load_dwordx4 v25, s[44:47], s8 offen offset:3072 lds
    s_add_u32 m0, s22, 4096
    s_add_u32 s8, s23, 212992
    buffer_load_dwordx4 v22, s[44:47], s8 offen lds
    buffer_load_dwordx4 v23, s[44:47], s8 offen offset:1024 lds
    buffer_load_dwordx4 v24, s[44:47], s8 offen offset:2048 lds
    buffer_load_dwordx4 v25, s[44:47], s8 offen offset:3072 lds
    s_add_u32 m0, s22, 8192
    s_add_u32 s8, s23, 245760
    buffer_load_dwordx4 v22, s[44:47], s8 offen lds
    buffer_load_dwordx4 v23, s[44:47], s8 offen offset:1024 lds
    buffer_load_dwordx4 v24, s[44:47], s8 offen offset:2048 lds
    buffer_load_dwordx4 v25, s[44:47], s8 offen offset:3072 lds
    s_add_u32 m0, s22, 12288
    s_add_u32 s8, s23, 278528
    buffer_load_dwordx4 v22, s[44:47], s8 offen lds
    buffer_load_dwordx4 v23, s[44:47], s8 offen offset:1024 lds
    buffer_load_dwordx4 v24, s[44:47], s8 offen offset:2048 lds
    buffer_load_dwordx4 v25, s[44:47], s8 offen offset:3072 lds
    s_waitcnt vmcnt(0)
    s_branch L_merge3
L_code_end:
    s_endpgm
.section .rodata,"a"
.p2align 6
.amdhsa_kernel sequential_preLN__sliding_local_dilated__dense_activation_gelu__prompt_kernel
  .amdhsa_next_free_vgpr 512
  .amdhsa_next_free_sgpr 102
  .amdhsa_accum_offset 256
  .amdhsa_group_segment_fixed_size 0
  .amdhsa_kernarg_size 88
  .amdhsa_user_sgpr_count 2
  .amdhsa_user_sgpr_kernarg_segment_ptr 1
  .amdhsa_system_sgpr_workgroup_id_x 1
.end_amdhsa_kernel
```
